```python
import torch

def _softmax(x, axis=-1):
    return torch.softmax(x, dim=axis)
def _gelu(x):
    return torch.nn.functional.gelu(x, approximate="tanh")
def _silu(x):
    return torch.nn.functional.silu(x)
def _sigmoid(x):
    return torch.sigmoid(x)
def _layernorm(x, axis=-1, eps=1e-5):
    m = x.mean(dim=axis, keepdim=True)
    v = x.var(dim=axis, keepdim=True, unbiased=False)
    return (x - m) / torch.sqrt(v + eps)
def _scatter_add(tgt, idx, src, axis=0):
    return tgt.clone().index_add_(axis, idx, src)
def _segment_sum(src, seg, n):
    out = torch.zeros((n,) + src.shape[1:], dtype=src.dtype)
    return out.index_add_(0, seg, src)
def _pad(x, pw):
    flat = tuple(v for pair in reversed(pw) for v in pair)
    return torch.nn.functional.pad(x, flat)

kernel_name = 'gated_mix__sliding_local_dilated__grouped_kv_mqa__prompt'

def setup_inputs():

    _w = (lambda a: (lambda t: t.to(torch.bfloat16) if t.is_floating_point() else t)(torch.as_tensor(a)))
    def _A_setup():
        B, S, D = 1, 2048, 640
        return {
            "x": _w((lambda *s: torch.randn(*s, dtype=torch.bfloat16) * 0.05)(B, S, D)),
            "wqkv": _w((lambda *s: torch.randn(*s, dtype=torch.bfloat16) * 0.8)(D, 3 * D)),
            "wo": _w((lambda *s: torch.randn(*s, dtype=torch.bfloat16) * 0.05)(D, D)),
        }
    _A_in = _A_setup()

    def _B_setup():
        B, S, D, H = 1, 2048, 640, 32
        Dh = D // H
        return {
            "x": _w((lambda *s: torch.randn(*s, dtype=torch.bfloat16) * 0.05)(B, S, D)),
            "wq": _w((lambda *s: torch.randn(*s, dtype=torch.bfloat16) * 1.6)(D, H * Dh)),
            "wk": _w((lambda *s: torch.randn(*s, dtype=torch.bfloat16) * 1.6)(D, Dh)),
            "wv": _w((lambda *s: torch.randn(*s, dtype=torch.bfloat16) * 0.2)(D, Dh)),
            "wo": _w((lambda *s: torch.randn(*s, dtype=torch.bfloat16) * 0.2)(H * Dh, D)),
        }
    _B_in = _B_setup()

    return {
        "A_x": _A_in["x"],
        "A_wqkv": _A_in["wqkv"],
        "A_wo": _A_in["wo"],
        "B_x": _B_in["x"],
        "B_wq": _B_in["wq"],
        "B_wk": _B_in["wk"],
        "B_wv": _B_in["wv"],
        "B_wo": _B_in["wo"],
        "gate_w": _w((lambda *s: torch.randn(*s, dtype=torch.bfloat16) * 0.05)(640) * 16.0),
    }

def reference(A_x, A_wqkv, A_wo, B_x, B_wq, B_wk, B_wv, B_wo, gate_w):
    def _A_ref(x, wqkv, wo):
        B, S, D = x.shape
        H = 32; Dh = D // H
        W, dil = 8, 2
        qkv = (lambda x, *d: x.permute(*d))((x @ wqkv).reshape(B, S, 3, H, Dh), 2, 0, 3, 1, 4)
        q, k, v = qkv[0], qkv[1], qkv[2]
        scale = Dh ** -0.5
        pos = torch.arange(S)
        off = torch.arange(W) * dil
        idx = pos[:, None] - off[None, :]
        mask = idx >= 0
        idx_c = torch.where(mask, idx, 0).reshape(-1)
        kg = k[:, :, idx_c, :].reshape(B, H, S, W, Dh)
        vg = v[:, :, idx_c, :].reshape(B, H, S, W, Dh)
        logits = torch.einsum("bhsd,bhswd->bhsw", q, kg) * scale
        logits = torch.where(mask[None, None, :, :], logits, -1e9)
        attn = _softmax(logits, axis=-1)
        o = torch.einsum("bhsw,bhswd->bhsd", attn, vg)
        return (lambda x, *d: x.permute(*d))(o, 0, 2, 1, 3).reshape(B, S, D) @ wo

    def _B_ref(x, wq, wk, wv, wo):
        B, S, D = x.shape
        H = 32
        Dh = D // H
        q = (lambda x, *d: x.permute(*d))((x @ wq).reshape(B, S, H, Dh), 0, 2, 1, 3)
        k = x @ wk
        v = x @ wv
        scores = torch.einsum("bhqd,bkd->bhqk", q, k) * (Dh ** -0.5)
        p = _softmax(scores, axis=-1)
        o = torch.einsum("bhqk,bkd->bhqd", p, v)
        return (lambda x, *d: x.permute(*d))(o, 0, 2, 1, 3).reshape(B, S, H * Dh) @ wo

    x = A_x
    g = _sigmoid((x * gate_w).sum(-1, keepdims=True))
    a = _A_ref(x, A_wqkv, A_wo)
    b = _B_ref(x, B_wq, B_wk, B_wv, B_wo)
    return g * a + (1 - g) * b
```

```asm
; @launch grid=(256,1,1) block=(512,1,1) lds=163840
.amdgcn_target "amdgcn-amd-amdhsa--gfx950"
.text
.globl gated_mix__sliding_local_dilated__grouped_kv_mqa__prompt_kernel
.p2align 8
.type gated_mix__sliding_local_dilated__grouped_kv_mqa__prompt_kernel,@function
gated_mix__sliding_local_dilated__grouped_kv_mqa__prompt_kernel:
    s_cmp_ge_u32 s2, 256
    s_cbranch_scc1 P_EXIT
    s_load_dwordx16 s[4:19], s[0:1], 0
    s_load_dwordx8 s[20:27], s[0:1], 64
    v_and_b32 v1, 63, v0
    v_lshrrev_b32 v2, 6, v0
    s_and_b32 s3, s2, 7
    v_readfirstlane_b32 s52, v2
    s_lshr_b32 s59, s3, 2
    s_lshr_b32 s60, s2, 5
    s_lshl3_add_u32 s54, s59, s60
    s_and_b32 s59, s3, 3
    s_bfe_u32 s61, s2, 0x20003
    s_lshl2_add_u32 s55, s59, s61
    s_add_u32 s60, s60, s61
    s_and_b32 s60, s60, 3
    s_lshl_b32 s60, s60, 2
    s_lshr_b32 s57, 29984, s60
    s_and_b32 s57, s57, 15
    s_bfe_u32 s53, s52, 0x10001
    s_and_b32 s60, s52, 1
    s_lshl1_add_u32 s53, s60, s53
    s_lshl2_add_u32 s56, s54, s53
    s_cmp_ge_u32 s52, 4
    s_cbranch_scc1 GB
    s_cmp_lg_u32 s52, 1
    s_cbranch_scc1 GA
    s_getpc_b64 s[72:73]
GA_PC:
    s_sub_u32 s72, s72, GA_PC-gated_mix__sliding_local_dilated__grouped_kv_mqa__prompt_kernel
    s_subb_u32 s73, s73, 0
    s_lshr_b32 s59, s2, 3
    s_lshl_b32 s59, s59, 10
    v_and_b32 v28, 7, v1
    v_lshlrev_b32 v28, 7, v28
    v_add_u32 v28, s59, v28
    v_min_u32 v28, CODE_END-gated_mix__sliding_local_dilated__grouped_kv_mqa__prompt_kernel-4, v28
    global_load_dword v254, v28, s[72:73]
    s_branch GA
P_EXIT:
    s_endpgm
GB:
    s_setprio 3
    s_mul_i32 s79, s53, 10240
    s_add_u32 s79, s79, 36864
    v_mov_b32 v24, 0
    v_mov_b32 v25, 0
    v_mov_b32 v26, 0
    v_mov_b32 v27, 0
    v_min_u32 v2, 31, v1
    v_lshlrev_b32 v2, 4, v2
    v_add_u32 v2, s79, v2
    v_add_u32 v3, 81920, v2
    ds_write_b128 v2, v[24:27] offset:9728
    ds_write_b128 v2, v[24:27] offset:50688
    ds_write_b128 v3, v[24:27] offset:9728
    s_lshr_b32 s59, s56, 1
    s_lshl_b32 s59, s59, 6
    s_and_b32 s60, s56, 1
    s_add_u32 s59, s59, s60
    s_mul_i32 s59, s59, 1280
    v_lshrrev_b32 v2, 3, v1
    v_mul_u32_u24 v3, 2560, v2
    v_add_u32 v3, s59, v3
    v_lshrrev_b32 v18, 1, v2
    v_and_b32 v19, 7, v1
    v_xor_b32 v18, v18, v19
    v_lshlrev_b32 v18, 4, v18
    v_xor_b32 v20, 64, v18
    v_add_u32 v4, v18, v3
    v_add_u32 v5, v20, v3
    v_add_u32 v6, 38912, v4
    v_add_u32 v7, 58368, v5
    v_add_u32 v5, 19456, v5
    s_mul_i32 s59, s53, 20480
    s_mul_i32 s60, s55, 80
    s_add_u32 s59, s59, s60
    v_lshrrev_b32 v2, 2, v1
    v_mul_u32_u24 v2, 1280, v2
    v_and_b32 v3, 3, v1
    v_lshl_add_u32 v2, v3, 4, v2
    v_and_b32 v3, 2, v1
    v_lshl_add_u32 v2, v3, 2, v2
    v_add_u32 v12, s59, v2
    v_lshrrev_b32 v2, 1, v1
    v_mul_u32_u24 v2, 1280, v2
    v_and_b32 v3, 1, v1
    v_lshl_add_u32 v2, v3, 5, v2
    v_add3_u32 v13, v2, s59, 32
    v_lshlrev_b32 v14, 4, v1
    v_lshlrev_b32 v17, 3, v1
    v_lshrrev_b32 v2, 4, v1
    v_lshlrev_b32 v3, 6, v2
    v_and_b32 v18, 0xf0, v14
    v_xor_b32 v3, v3, v18
    v_mul_u32_u24 v2, 3840, v2
    s_mul_i32 s59, s53, 61440
    s_lshl_b32 s60, s55, 8
    s_add_u32 s59, s59, s60
    v_add3_u32 v8, v2, v3, s59
    v_add_u32 v9, 14336, v8
    v_add_u32 v10, 28672, v8
    v_add_u32 v11, 43008, v8
    s_lshl_b32 s59, s53, 5
    v_add_u32 v21, s59, v1
    v_mov_b32 v15, 162304
    v_mov_b32 v16, 1
    s_mov_b32 s66, s57
    s_waitcnt lgkmcnt(0)
    s_mov_b32 s28, s4
    s_and_b32 s29, s5, 0xffff
    s_mov_b32 s30, 2621440
    s_mov_b32 s31, 0x00020000
    s_mov_b32 s44, s12
    s_and_b32 s45, s13, 0xffff
    s_mov_b32 s46, 819200
    s_mov_b32 s47, 0x00020000
    s_mov_b32 s92, s20
    s_and_b32 s93, s21, 0xffff
    s_mov_b32 s94, 1280
    s_mov_b32 s95, 0x00020000
    s_mov_b32 s40, s6
    s_and_b32 s41, s7, 0xffff
    s_mov_b32 s42, 2457600
    s_mov_b32 s43, 0x00020000
    s_mov_b32 s32, s16
    s_and_b32 s33, s17, 0xffff
    s_mov_b32 s34, 25600
    s_mov_b32 s35, 0x00020000
    s_cmp_lg_u32 s55, 15
    s_cbranch_scc1 GB_NS
    s_mov_b32 s40, s14
    s_and_b32 s41, s15, 0xffff
    s_mov_b32 s42, 25600
    s_mov_b32 s43, 0x00020000
    s_mul_i32 s59, s53, 640
    v_add_u32 v8, s59, v14
GB_NS:
    s_lshl_b32 s59, s66, 7
    s_mov_b32 m0, s79
    s_nop 0
    buffer_load_dwordx4 v4, s[28:31], s59 offen offset:0 lds
    buffer_load_dwordx4 v5, s[28:31], s59 offen offset:1024 lds
    buffer_load_dwordx4 v6, s[28:31], s59 offen offset:2048 lds
    buffer_load_dwordx4 v7, s[28:31], s59 offen offset:3072 lds
    s_add_u32 m0, s79, 4096
    s_cmp_eq_u32 s55, 15
    s_cbranch_scc1 DS_0
    s_mul_i32 s61, s66, 245760
    buffer_load_dwordx4 v8, s[40:43], s61 offen offset:0 lds
    buffer_load_dwordx4 v9, s[40:43], s61 offen offset:1024 lds
    buffer_load_dwordx4 v10, s[40:43], s61 offen offset:2048 lds
    buffer_load_dwordx4 v11, s[40:43], s61 offen offset:3072 lds
    s_branch DD_0
DS_0:
    s_mul_i32 s61, s66, 2560
    s_mov_b32 exec_hi, 0xff
    buffer_load_dwordx4 v8, s[40:43], s61 offen lds
    s_add_u32 m0, s79, 5120
    s_nop 0
    buffer_load_dwordx4 v8, s[32:35], s61 offen lds
    s_mov_b32 exec_hi, -1
DD_0:
    s_add_u32 m0, s79, 8192
    s_mul_i32 s60, s66, 81920
    s_lshl_b32 s59, s66, 7
    buffer_load_dwordx4 v12, s[44:47], s60 offen lds
    s_add_u32 m0, s79, 9216
    s_mov_b32 exec_hi, 0
    buffer_load_dwordx4 v13, s[44:47], s60 offen lds
    s_add_u32 m0, s79, 9856
    s_mov_b32 exec_lo, 0x55555555
    buffer_load_ushort v21, s[92:95], s59 offen lds
    s_mov_b64 exec, -1
    s_add_u32 s66, s66, 1
    s_cmp_eq_u32 s66, 10
    s_cselect_b32 s66, 0, s66
    s_add_u32 s79, s79, 40960
    s_cmp_ge_u32 s79, 159744
    s_cselect_b32 s60, 122880, 0
    s_sub_u32 s79, s79, s60
    v_mov_b64 v[192:193], 0
    v_mov_b64 v[194:195], 0
    v_mov_b64 v[196:197], 0
    v_mov_b64 v[198:199], 0
    v_mov_b64 v[200:201], 0
    v_mov_b64 v[202:203], 0
    v_mov_b64 v[204:205], 0
    v_mov_b64 v[206:207], 0
    v_mov_b64 v[208:209], 0
    v_mov_b64 v[210:211], 0
    v_mov_b64 v[212:213], 0
    v_mov_b64 v[214:215], 0
    v_mov_b64 v[216:217], 0
    v_mov_b64 v[218:219], 0
    v_mov_b64 v[220:221], 0
    v_mov_b64 v[222:223], 0
    s_cmp_ge_u32 s56, 2
    s_cselect_b32 s63, 2, 0
    s_sub_u32 s59, s56, s63
    s_lshl_b32 s59, s59, 6
    s_add_u32 s67, s59, 14950400
    s_mul_i32 s91, s63, 122880
    s_lshl_b32 s71, s53, 13
    s_add_u32 s71, s71, 129024
    s_lshr_b32 s61, s53, 1
    s_and_b32 s62, s53, 1
    s_mul_i32 s69, s61, 409600
    s_and_b32 s59, s55, 7
    s_mul_i32 s59, s59, 160
    s_add_u32 s69, s69, s59
    s_lshr_b32 s59, s55, 3
    s_lshl1_add_u32 s59, s59, s62
    s_lshl2_add_u32 s60, s54, s59
    s_mul_i32 s90, s60, 81920
    s_mul_i32 s59, s61, 20480
    s_add_u32 s90, s90, s59
    s_add_u32 s90, s90, 8388608
    s_lshl_b32 s59, s60, 6
    s_add_u32 s68, s59, 14958592
    s_mov_b32 s87, 0x3ea52b5c
    s_and_b32 s59, s2, 7
    s_lshl_b32 s59, s59, 11
    s_add_u32 s85, s59, 14974976
    v_and_b32 v23, 15, v1
    v_lshlrev_b32 v23, 7, v23
    s_mul_i32 s70, s56, 81920
    s_mul_i32 s59, s55, 2560
    s_add_u32 s70, s70, s59
    s_add_u32 s70, s70, 8388608
    s_mul_i32 s59, s53, 5120
    v_add_u32 v3, s59, v14
    s_lshl_b32 s59, s66, 7
    s_mov_b32 m0, s79
    s_nop 0
    buffer_load_dwordx4 v4, s[28:31], s59 offen offset:0 lds
    buffer_load_dwordx4 v5, s[28:31], s59 offen offset:1024 lds
    buffer_load_dwordx4 v6, s[28:31], s59 offen offset:2048 lds
    buffer_load_dwordx4 v7, s[28:31], s59 offen offset:3072 lds
    s_add_u32 m0, s79, 4096
    s_cmp_eq_u32 s55, 15
    s_cbranch_scc1 DS_1
    s_mul_i32 s61, s66, 245760
    buffer_load_dwordx4 v8, s[40:43], s61 offen offset:0 lds
    buffer_load_dwordx4 v9, s[40:43], s61 offen offset:1024 lds
    buffer_load_dwordx4 v10, s[40:43], s61 offen offset:2048 lds
    buffer_load_dwordx4 v11, s[40:43], s61 offen offset:3072 lds
    s_branch DD_1
DS_1:
    s_mul_i32 s61, s66, 2560
    s_mov_b32 exec_hi, 0xff
    buffer_load_dwordx4 v8, s[40:43], s61 offen lds
    s_add_u32 m0, s79, 5120
    s_nop 0
    buffer_load_dwordx4 v8, s[32:35], s61 offen lds
    s_mov_b32 exec_hi, -1
DD_1:
    s_add_u32 m0, s79, 8192
    s_mul_i32 s60, s66, 81920
    s_lshl_b32 s59, s66, 7
    buffer_load_dwordx4 v12, s[44:47], s60 offen lds
    s_add_u32 m0, s79, 9216
    s_mov_b32 exec_hi, 0
    buffer_load_dwordx4 v13, s[44:47], s60 offen lds
    s_add_u32 m0, s79, 9856
    s_mov_b32 exec_lo, 0x55555555
    buffer_load_ushort v21, s[92:95], s59 offen lds
    s_mov_b64 exec, -1
    s_add_u32 s66, s66, 1
    s_cmp_eq_u32 s66, 10
    s_cselect_b32 s66, 0, s66
    s_add_u32 s79, s79, 40960
    s_cmp_ge_u32 s79, 159744
    s_cselect_b32 s60, 122880, 0
    s_sub_u32 s79, s79, s60
    s_mov_b32 s36, s26
    s_and_b32 s37, s27, 0xffff
    s_mov_b32 s38, 20971520
    s_mov_b32 s39, 0x00020000
    s_cmp_lg_u32 s55, 15
    s_cbranch_scc1 DW_0
    s_waitcnt vmcnt(9)
DW_0:
    s_waitcnt vmcnt(11) lgkmcnt(0)
    s_barrier
    ds_read_b128 v[160:163], v14 offset:0
    ds_read_b128 v[164:167], v14 offset:1024
    ds_read_b128 v[168:171], v14 offset:2048
    ds_read_b128 v[172:175], v14 offset:3072
    ds_read_b128 v[228:231], v14 offset:4096
    ds_read_b128 v[232:235], v14 offset:5120
    ds_read_b128 v[176:179], v3 offset:6144
    ds_read_b128 v[224:227], v3 offset:7168
    ds_read_b128 v[236:239], v3 offset:8192
    ds_read_b128 v[240:243], v3 offset:9216
    ds_read_b128 v[244:247], v3 offset:10240
    s_lshl_b32 s59, s66, 7
    s_mov_b32 m0, s79
    s_nop 0
    buffer_load_dwordx4 v4, s[28:31], s59 offen offset:0 lds
    buffer_load_dwordx4 v5, s[28:31], s59 offen offset:1024 lds
    buffer_load_dwordx4 v6, s[28:31], s59 offen offset:2048 lds
    buffer_load_dwordx4 v7, s[28:31], s59 offen offset:3072 lds
    s_add_u32 m0, s79, 4096
    s_cmp_eq_u32 s55, 15
    s_cbranch_scc1 DS_2
    s_mul_i32 s61, s66, 245760
    buffer_load_dwordx4 v8, s[40:43], s61 offen offset:0 lds
    buffer_load_dwordx4 v9, s[40:43], s61 offen offset:1024 lds
    buffer_load_dwordx4 v10, s[40:43], s61 offen offset:2048 lds
    buffer_load_dwordx4 v11, s[40:43], s61 offen offset:3072 lds
    s_branch DD_2
DS_2:
    s_mul_i32 s61, s66, 2560
    s_mov_b32 exec_hi, 0xff
    buffer_load_dwordx4 v8, s[40:43], s61 offen lds
    s_add_u32 m0, s79, 5120
    s_nop 0
    buffer_load_dwordx4 v8, s[32:35], s61 offen lds
    s_mov_b32 exec_hi, -1
DD_2:
    s_add_u32 m0, s79, 8192
    s_mul_i32 s60, s66, 81920
    s_lshl_b32 s59, s66, 7
    buffer_load_dwordx4 v12, s[44:47], s60 offen lds
    s_add_u32 m0, s79, 9216
    s_mov_b32 exec_hi, 0
    buffer_load_dwordx4 v13, s[44:47], s60 offen lds
    s_add_u32 m0, s79, 9856
    s_mov_b32 exec_lo, 0x55555555
    buffer_load_ushort v21, s[92:95], s59 offen lds
    s_mov_b64 exec, -1
    s_add_u32 s66, s66, 1
    s_cmp_eq_u32 s66, 10
    s_cselect_b32 s66, 0, s66
    s_add_u32 s79, s79, 40960
    s_cmp_ge_u32 s79, 159744
    s_cselect_b32 s60, 122880, 0
    s_sub_u32 s79, s79, s60
    v_mov_b32 v22, 0
    s_mov_b32 s65, 1
GB_L1:
    s_cmp_lg_u32 s55, 15
    s_cbranch_scc1 DW_L
    s_waitcnt vmcnt(9)
DW_L:
    s_waitcnt vmcnt(11) lgkmcnt(0)
    s_barrier
    s_lshl_b32 s59, s66, 7
    s_mov_b32 m0, s79
    s_nop 0
    buffer_load_dwordx4 v4, s[28:31], s59 offen offset:0 lds
    buffer_load_dwordx4 v5, s[28:31], s59 offen offset:1024 lds
    buffer_load_dwordx4 v6, s[28:31], s59 offen offset:2048 lds
    buffer_load_dwordx4 v7, s[28:31], s59 offen offset:3072 lds
    s_add_u32 m0, s79, 4096
    s_cmp_eq_u32 s55, 15
    s_cbranch_scc1 DS_L
    s_mul_i32 s61, s66, 245760
    buffer_load_dwordx4 v8, s[40:43], s61 offen offset:0 lds
    buffer_load_dwordx4 v9, s[40:43], s61 offen offset:1024 lds
    buffer_load_dwordx4 v10, s[40:43], s61 offen offset:2048 lds
    buffer_load_dwordx4 v11, s[40:43], s61 offen offset:3072 lds
    s_branch DD_L
DS_L:
    s_mul_i32 s61, s66, 2560
    s_mov_b32 exec_hi, 0xff
    buffer_load_dwordx4 v8, s[40:43], s61 offen lds
    s_add_u32 m0, s79, 5120
    s_nop 0
    buffer_load_dwordx4 v8, s[32:35], s61 offen lds
    s_mov_b32 exec_hi, -1
DD_L:
    s_add_u32 m0, s79, 8192
    s_mul_i32 s60, s66, 81920
    s_lshl_b32 s59, s66, 7
    buffer_load_dwordx4 v12, s[44:47], s60 offen lds
    s_add_u32 m0, s79, 9216
    s_mov_b32 exec_hi, 0
    buffer_load_dwordx4 v13, s[44:47], s60 offen lds
    s_add_u32 m0, s79, 9856
    s_mov_b32 exec_lo, 0x55555555
    buffer_load_ushort v21, s[92:95], s59 offen lds
    s_mov_b64 exec, -1
    s_add_u32 s66, s66, 1
    s_cmp_eq_u32 s66, 10
    s_cselect_b32 s66, 0, s66
    s_add_u32 s79, s79, 40960
    s_cmp_ge_u32 s79, 159744
    s_cselect_b32 s60, 122880, 0
    s_sub_u32 s79, s79, s60
    s_lshl_b32 s59, s53, 4
    s_add_u32 s59, s59, s65
    s_cmp_lg_u32 s59, 2
    s_cbranch_scc1 GB_L1B
    global_load_dword v22, v22, s[24:25] sc1
GB_L1B:
    s_add_u32 s65, s65, 1
    s_cmp_lt_u32 s65, 8
    s_cbranch_scc1 GB_L1
    s_cmp_lg_u32 s55, 15
    s_cbranch_scc1 DW_2
    s_waitcnt vmcnt(9)
DW_2:
    s_waitcnt vmcnt(11) lgkmcnt(0)
    s_barrier
    s_and_b32 s62, s54, 14
    s_cmp_lg_u32 s53, 0
    s_cbranch_scc1 GB_E9
    v_readfirstlane_b32 s58, v22
    s_nop 3
    s_cmp_lg_u32 s58, 0
    s_cbranch_scc1 NOND_B
    s_mov_b32 s48, s24
    s_and_b32 s49, s25, 0xffff
    s_mov_b32 s50, 256
    s_mov_b32 s51, 0x00020000
    v_mov_b32 v2, 0
    s_mov_b32 s86, 0
NON_B:
    buffer_load_dword v3, v2, s[48:51], 0 offen sc1
    s_add_u32 s86, s86, 1
    s_waitcnt vmcnt(0)
    v_readfirstlane_b32 s58, v3
    s_cmp_gt_u32 s86, 200000
    s_cbranch_scc1 NOND_B
    s_cmp_eq_u32 s58, 0
    s_cbranch_scc1 NON_B
NOND_B:
    v_mov_b32 v3, s58
    ds_write_b32 v15, v3 offset:8
    buffer_load_dword v18, v23, s[36:39], s85 offen sc1
    s_waitcnt vmcnt(1)
    s_mov_b64 exec, 1
    ds_add_u32 v15, v16 offset:112
    s_mov_b64 exec, -1
    s_waitcnt vmcnt(0)
    v_cmp_eq_u32 vcc, s58, v18
    s_nop 4
    s_lshr_b64 s[74:75], vcc, s62
    s_lshr_b32 s59, s74, 1
    s_lshr_b32 s60, s74, 2
    s_and_b32 s59, s59, s74
    s_and_b32 s59, s59, s60
    s_and_b32 s59, s59, 0x5555
    s_cbranch_scc0 GB_KV0
    s_ff1_i32_b32 s59, s59
GB_KVFE:
    s_add_u32 s59, s59, s62
    s_and_b32 s59, s59, 15
    s_add_u32 s59, s59, 1
    v_mov_b32 v2, s59
    ds_write_b32 v15, v2 offset:12
    s_branch GB_KVW
GB_E9:
    s_waitcnt vmcnt(0)
    s_mov_b64 exec, 1
    ds_add_u32 v15, v16 offset:112
    s_mov_b64 exec, -1
    s_branch GB_KVW
GB_KV0:
    s_cmp_lg_u32 s55, 15
    s_cbranch_scc1 GB_KVP
    s_mov_b32 s86, 0
LW_KVS:
    ds_read_b32 v2, v15 offset:4
    s_add_u32 s86, s86, 1
    s_waitcnt lgkmcnt(0)
    v_readfirstlane_b32 s64, v2
    s_cmp_gt_u32 s86, 1600000
    s_cbranch_scc1 LWD_KVS
    s_cmp_ge_u32 s64, 2
    s_cbranch_scc1 LWD_KVS
    s_sleep 2
    s_branch LW_KVS
LWD_KVS:
GB_KVP:
    s_and_b32 s62, s54, 14
    s_mov_b32 s86, 0
    s_branch GB_KVL
GB_KVM:
    s_sleep 4
GB_KVL:
    buffer_load_dword v18, v23, s[36:39], s85 offen sc1
    s_add_u32 s86, s86, 1
    s_mov_b32 s59, 0
    s_cmp_gt_u32 s86, 200000
    s_cbranch_scc1 GB_KVFL
    s_waitcnt vmcnt(0)
    v_cmp_eq_u32 vcc, s58, v18
    s_nop 4
    s_lshr_b64 s[74:75], vcc, s62
    s_lshr_b32 s59, s74, 1
    s_lshr_b32 s60, s74, 2
    s_and_b32 s59, s59, s74
    s_and_b32 s59, s59, s60
    s_and_b32 s59, s59, 0x5555
    s_cbranch_scc0 GB_KVM
    s_ff1_i32_b32 s59, s59
GB_KVFL:
    s_add_u32 s59, s59, s62
    s_and_b32 s59, s59, 15
    s_add_u32 s59, s59, 1
    v_mov_b32 v2, s59
    ds_write_b32 v15, v2 offset:12
GB_KVW:
    s_mov_b32 s86, 0
LW_KV:
    ds_read_b32 v3, v15 offset:12
    s_add_u32 s86, s86, 1
    s_waitcnt lgkmcnt(0)
    v_readfirstlane_b32 s64, v3
    s_cmp_gt_u32 s86, 1600000
    s_cbranch_scc1 LWD_KV
    s_cmp_ge_u32 s64, 1
    s_cbranch_scc1 LWD_KV
    s_sleep 1
    s_branch LW_KV
LWD_KV:
    ds_read_b32 v22, v15 offset:8
    s_sub_u32 s78, s64, 1
    s_and_b32 s78, s78, 15
    s_mul_i32 s78, s78, 10752
    s_lshl_b32 s59, s53, 10
    s_add_u32 s60, s59, s78
    s_add_u32 s60, s60, 14680064
    s_add_u32 s59, s59, 0
KV_0:
    s_cmp_ge_u32 s60, 14852096
    s_cselect_b32 s61, 172032, 0
    s_mov_b32 m0, s59
    s_sub_u32 s60, s60, s61
    s_add_u32 s59, s59, 4096
    buffer_load_dwordx4 v14, s[36:39], s60 offen sc1 lds
    s_add_u32 s60, s60, 4096
    s_cmp_lt_u32 s59, 32768
    s_cbranch_scc1 KV_0
    s_mov_b32 s48, s8
    s_and_b32 s49, s9, 0xffff
    s_mov_b32 s50, 819200
    s_mov_b32 s51, 0x00020000
    s_mov_b32 s32, s18
    s_and_b32 s33, s19, 0xffff
    s_mov_b32 s34, 819200
    s_mov_b32 s35, 0x00020000
    s_and_b32 s62, s53, 1
    s_lshl_b32 s62, s62, 1
    s_lshl2_add_u32 s64, s54, s62
    s_mul_i32 s66, s64, 122880
    s_lshl_b32 s59, s55, 13
    s_add_u32 s66, s66, s59
    s_cmp_eq_u32 s55, 15
    s_cselect_b32 s66, 20971520, s66
    s_lshl_b32 s65, s64, 4
    s_add_u32 s65, s65, s55
    s_lshl_b32 s65, s65, 2
    s_add_u32 s65, s65, 14950400
    s_lshl_b32 s62, s62, 13
    s_add_u32 s62, s62, 129024
    v_and_b32 v2, 0x200, v14
    v_and_b32 v3, 0xf8, v17
    v_add3_u32 v2, v2, v3, s62
    s_lshl_b32 s63, s56, 4
    s_add_u32 s63, s63, s55
    s_lshl_b32 s63, s63, 2
    s_waitcnt lgkmcnt(0)
    v_readfirstlane_b32 s58, v22
    s_cmp_lg_u32 s53, 0
    s_cbranch_scc1 GB_BK
    buffer_load_dword v18, v23, s[36:39], s85 offen sc1
    s_waitcnt vmcnt(0)
    v_cmp_ne_u32 vcc, s58, v18
    s_nop 4
    s_cbranch_vccnz GB_BK4
    s_mov_b64 exec, 1
    ds_add_u32 v15, v16 offset:104
    s_mov_b64 exec, -1
GB_BK:
    s_waitcnt vmcnt(0)
    s_barrier
    s_branch GB_KVW2
GB_BK4:
    s_barrier
    s_mov_b32 s86, 0
PF_KV:
    buffer_load_dword v18, v23, s[36:39], s85 offen offset:0 sc1
    s_add_u32 s86, s86, 1
    s_cmp_gt_u32 s86, 200000
    s_cbranch_scc1 PFD_KV
    s_waitcnt vmcnt(0)
    v_xor_b32 v18, s58, v18
    v_cmp_ne_u32 vcc, 0, v18
    s_nop 4
    s_cbranch_vccz PFD_KV
    s_sleep 4
    s_branch PF_KV
PFD_KV:
    s_mov_b64 exec, 1
    ds_add_u32 v15, v16 offset:104
    s_mov_b64 exec, -1
GB_KVW2:
    s_cmp_lt_u32 s53, 2
    s_cbranch_scc1 GB_KVJ
    ds_read2_b64 v[96:99], v2 offset0:0 offset1:32
    ds_read2_b64 v[100:103], v2 offset0:128 offset1:160
    v_add_u32 v2, 2048, v2
    ds_read2_b64 v[104:107], v2 offset0:0 offset1:32
    ds_read2_b64 v[108:111], v2 offset0:128 offset1:160
    v_add_u32 v2, 2048, v2
    ds_read2_b64 v[112:115], v2 offset0:0 offset1:32
    ds_read2_b64 v[116:119], v2 offset0:128 offset1:160
    v_add_u32 v2, 2048, v2
    ds_read2_b64 v[120:123], v2 offset0:0 offset1:32
    ds_read2_b64 v[124:127], v2 offset0:128 offset1:160
    v_add_u32 v2, 2048, v2
    s_add_u32 s62, s66, 4096
    s_waitcnt lgkmcnt(7)
    buffer_store_dwordx4 v[96:99], v14, s[36:39], s66 offen offset:0 sc1
    s_waitcnt lgkmcnt(6)
    buffer_store_dwordx4 v[100:103], v14, s[36:39], s66 offen offset:1024 sc1
    s_waitcnt lgkmcnt(5)
    buffer_store_dwordx4 v[104:107], v14, s[36:39], s66 offen offset:2048 sc1
    s_waitcnt lgkmcnt(4)
    buffer_store_dwordx4 v[108:111], v14, s[36:39], s66 offen offset:3072 sc1
    s_waitcnt lgkmcnt(3)
    buffer_store_dwordx4 v[112:115], v14, s[36:39], s62 offen offset:0 sc1
    s_waitcnt lgkmcnt(2)
    buffer_store_dwordx4 v[116:119], v14, s[36:39], s62 offen offset:1024 sc1
    s_waitcnt lgkmcnt(1)
    buffer_store_dwordx4 v[120:123], v14, s[36:39], s62 offen offset:2048 sc1
    s_waitcnt lgkmcnt(0)
    buffer_store_dwordx4 v[124:127], v14, s[36:39], s62 offen offset:3072 sc1
    s_add_u32 s66, s66, 122880
    s_add_u32 s62, s62, 122880
    ds_read2_b64 v[128:131], v2 offset0:0 offset1:32
    ds_read2_b64 v[132:135], v2 offset0:128 offset1:160
    v_add_u32 v2, 2048, v2
    ds_read2_b64 v[136:139], v2 offset0:0 offset1:32
    ds_read2_b64 v[140:143], v2 offset0:128 offset1:160
    v_add_u32 v2, 2048, v2
    ds_read2_b64 v[144:147], v2 offset0:0 offset1:32
    ds_read2_b64 v[148:151], v2 offset0:128 offset1:160
    v_add_u32 v2, 2048, v2
    ds_read2_b64 v[152:155], v2 offset0:0 offset1:32
    ds_read2_b64 v[156:159], v2 offset0:128 offset1:160
    v_add_u32 v2, 2048, v2
    s_waitcnt lgkmcnt(7)
    buffer_store_dwordx4 v[128:131], v14, s[36:39], s66 offen offset:0 sc1
    s_waitcnt lgkmcnt(6)
    buffer_store_dwordx4 v[132:135], v14, s[36:39], s66 offen offset:1024 sc1
    s_waitcnt lgkmcnt(5)
    buffer_store_dwordx4 v[136:139], v14, s[36:39], s66 offen offset:2048 sc1
    s_waitcnt lgkmcnt(4)
    buffer_store_dwordx4 v[140:143], v14, s[36:39], s66 offen offset:3072 sc1
    s_waitcnt lgkmcnt(3)
    buffer_store_dwordx4 v[144:147], v14, s[36:39], s62 offen offset:0 sc1
    s_waitcnt lgkmcnt(2)
    buffer_store_dwordx4 v[148:151], v14, s[36:39], s62 offen offset:1024 sc1
    s_waitcnt lgkmcnt(1)
    buffer_store_dwordx4 v[152:155], v14, s[36:39], s62 offen offset:2048 sc1
    s_waitcnt lgkmcnt(0)
    buffer_store_dwordx4 v[156:159], v14, s[36:39], s62 offen offset:3072 sc1
    s_mov_b64 exec, 1
    ds_add_u32 v15, v16 offset:108
    s_mov_b64 exec, -1
    v_lshlrev_b32 v2, 6, v1
    v_mov_b32 v3, s58
    s_waitcnt vmcnt(0)
    s_mov_b64 exec, 3
    buffer_store_dword v3, v2, s[36:39], s65 offen sc1
    s_mov_b64 exec, -1
    s_branch GB_CLR
GB_KVJ:
    s_mov_b32 s86, 0
LW_KV2:
    ds_read_b32 v3, v15 offset:104
    s_add_u32 s86, s86, 1
    s_waitcnt lgkmcnt(0)
    v_readfirstlane_b32 s64, v3
    s_cmp_gt_u32 s86, 1600000
    s_cbranch_scc1 LWD_KV2
    s_cmp_ge_u32 s64, 1
    s_cbranch_scc1 LWD_KV2
    s_sleep 1
    s_branch LW_KV2
LWD_KV2:
    s_lshl_b32 s59, s53, 10
    s_add_u32 s60, s59, s78
    s_add_u32 s60, s60, 14711808
    s_add_u32 s59, s59, 31744
KV_1:
    s_cmp_ge_u32 s60, 14852096
    s_cselect_b32 s61, 172032, 0
    s_mov_b32 m0, s59
    s_sub_u32 s60, s60, s61
    s_add_u32 s59, s59, 2048
    buffer_load_dwordx4 v14, s[36:39], s60 offen sc1 lds
    s_add_u32 s60, s60, 2048
    s_cmp_lt_u32 s59, 76800
    s_cbranch_scc1 KV_1
    s_mov_b32 s86, 0
LW_QC:
    ds_read_b32 v3, v15 offset:96
    s_add_u32 s86, s86, 1
    s_waitcnt lgkmcnt(0)
    v_readfirstlane_b32 s64, v3
    s_cmp_gt_u32 s86, 1600000
    s_cbranch_scc1 LWD_QC
    s_cmp_ge_u32 s64, 2
    s_cbranch_scc1 LWD_QC
    s_sleep 1
    s_branch LW_QC
LWD_QC:
    s_waitcnt vmcnt(0)
    s_mov_b64 exec, 1
    ds_add_u32 v15, v16 offset:16
    s_mov_b64 exec, -1
    s_mov_b64 exec, 1
    ds_add_u32 v15, v16 offset:16
    s_mov_b64 exec, -1
    s_lshl_b32 s59, s53, 10
    s_add_u32 s60, s59, s78
    s_add_u32 s60, s60, 14756864
    s_add_u32 s59, s59, 76800
KV_2:
    s_cmp_ge_u32 s60, 14852096
    s_cselect_b32 s61, 172032, 0
    s_mov_b32 m0, s59
    s_sub_u32 s60, s60, s61
    s_add_u32 s59, s59, 2048
    buffer_load_dwordx4 v14, s[36:39], s60 offen sc1 lds
    s_add_u32 s60, s60, 2048
    s_cmp_lt_u32 s59, 129024
    s_cbranch_scc1 KV_2
GB_CLR:
    s_add_u32 s64, s70, 40960
    v_mov_b32 v18, -1
    v_mov_b32 v19, -1
    v_mov_b32 v20, -1
    v_mov_b32 v21, -1
    buffer_store_dwordx4 v[18:21], v14, s[36:39], s64 offen sc1
    buffer_store_dwordx4 v[18:21], v14, s[36:39], s64 offen offset:1024 sc1
    buffer_store_dwordx2 v[18:19], v17, s[36:39], s64 offen offset:2048 sc1
    s_lshr_b32 s59, s2, 3
    s_lshl2_add_u32 s59, s59, s53
    s_and_b32 s60, s59, 63
    s_mul_i32 s60, s60, 12800
    s_and_b32 s61, s2, 1
    s_mul_i32 s61, s61, 640
    s_add_u32 s60, s60, s61
    s_cmp_lt_u32 s59, 64
    s_cbranch_scc1 GB_WARMA
    buffer_load_dword v3, v240, s[32:35], s60 offen
    s_branch GB_WARMD
GB_WARMA:
    buffer_load_dword v3, v240, s[48:51], s60 offen
GB_WARMD:
    s_waitcnt vmcnt(1)
    s_mov_b64 exec, 1
    ds_add_u32 v15, v16 offset:20
    s_mov_b64 exec, -1
    s_mov_b32 s86, 0
PF_AF:
    buffer_load_dword v18, v238, s[36:39], s67 offen offset:0 sc1
    s_add_u32 s86, s86, 1
    s_cmp_gt_u32 s86, 200000
    s_cbranch_scc1 PFD_AF
    s_waitcnt vmcnt(0)
    v_xor_b32 v18, s58, v18
    v_cmp_ne_u32 vcc, 0, v18
    s_nop 4
    s_cbranch_vccz PFD_AF
    s_sleep 4
    s_branch PF_AF
PFD_AF:
    s_mov_b32 s86, 0
LW_ST:
    ds_read_b32 v3, v15 offset:108
    s_add_u32 s86, s86, 1
    s_waitcnt lgkmcnt(0)
    v_readfirstlane_b32 s64, v3
    s_cmp_gt_u32 s86, 1600000
    s_cbranch_scc1 LWD_ST
    s_cmp_ge_u32 s64, 2
    s_cbranch_scc1 LWD_ST
    s_sleep 1
    s_branch LW_ST
LWD_ST:
    s_mul_i32 s59, s56, 122880
    s_mul_i32 s60, s55, 2560
    s_add_u32 s59, s59, s60
    buffer_load_dwordx4 v[24:27], v14, s[36:39], s59 offen sc1
    buffer_load_dwordx4 v[28:31], v14, s[36:39], s59 offen offset:1536 sc1
    buffer_load_dwordx2 v[32:33], v235, s[36:39], s59 offen offset:1024 sc1
    s_add_u32 s59, s59, 40960
    buffer_load_dwordx4 v[36:39], v14, s[36:39], s59 offen sc1
    buffer_load_dwordx4 v[40:43], v14, s[36:39], s59 offen offset:1536 sc1
    buffer_load_dwordx2 v[44:45], v235, s[36:39], s59 offen offset:1024 sc1
    s_sub_u32 s60, s59, s91
    buffer_load_dwordx4 v[48:51], v14, s[36:39], s60 offen sc1
    buffer_load_dwordx4 v[52:55], v14, s[36:39], s60 offen offset:1536 sc1
    buffer_load_dwordx2 v[56:57], v235, s[36:39], s60 offen offset:1024 sc1
    s_add_u32 s59, s59, 40960
    s_mov_b32 m0, s71
    s_sub_u32 s60, s59, s91
    buffer_load_dwordx4 v14, s[36:39], s59 offen offset:0 sc1 lds
    buffer_load_dwordx4 v14, s[36:39], s59 offen offset:1024 sc1 lds
    buffer_load_dwordx4 v14, s[36:39], s59 offen offset:2048 sc1 lds
    s_add_u32 m0, s71, 3072
    ds_read_b32 v243, v242
    buffer_load_dwordx4 v14, s[36:39], s60 offen offset:0 sc1 lds
    buffer_load_dwordx4 v14, s[36:39], s60 offen offset:1024 sc1 lds
    buffer_load_dwordx4 v14, s[36:39], s60 offen offset:2048 sc1 lds
    s_waitcnt vmcnt(6)
    v_mfma_f32_32x32x16_bf16 v[96:111], v[36:39], v[24:27], v[160:175]
    v_mfma_f32_32x32x16_bf16 v[112:127], v[40:43], v[28:31], v[160:175]
    v_mfma_f32_32x32x16_bf16 v[128:143], v[48:51], v[24:27], v[164:179]
    v_mfma_f32_32x32x16_bf16 v[144:159], v[52:55], v[28:31], v[164:179]
    s_nop 7
    v_mfma_f32_32x32x4_2b_bf16 v[96:127], v[44:45], v[32:33], v[96:127]
    s_nop 7
    v_mfma_f32_32x32x4_2b_bf16 v[128:159], v[56:57], v[32:33], v[128:159]
    s_waitcnt vmcnt(0)
    ds_read_b64_tr_b16 v[60:61], v236 offset:0
    ds_read_b64_tr_b16 v[62:63], v236 offset:64
    ds_read_b64_tr_b16 v[64:65], v236 offset:256
    ds_read_b64_tr_b16 v[66:67], v236 offset:320
    ds_read_b64_tr_b16 v[68:69], v236 offset:3328
    ds_read_b64_tr_b16 v[70:71], v236 offset:3392
    ds_read_b64_tr_b16 v[72:73], v237 offset:0
    ds_read_b64_tr_b16 v[74:75], v237 offset:64
    ds_read_b64_tr_b16 v[76:77], v237 offset:256
    ds_read_b64_tr_b16 v[78:79], v237 offset:320
    ds_read_b64_tr_b16 v[80:81], v237 offset:3328
    ds_read_b64_tr_b16 v[82:83], v237 offset:3392
    s_nop 7
    s_waitcnt lgkmcnt(0)
    s_mov_b32 exec_lo, 0x11000000
    s_mov_b32 exec_hi, 0x11000000
    s_mov_b32 s74, 0x3f803f80
    s_mov_b32 s75, 0x3f803f80
    v_mov_b64 v[60:61], s[74:75]
    v_mov_b64 v[62:63], s[74:75]
    v_mov_b64 v[64:65], s[74:75]
    v_mov_b64 v[66:67], s[74:75]
    v_mov_b64 v[68:69], s[74:75]
    v_mov_b64 v[70:71], s[74:75]
    v_mov_b64 v[72:73], s[74:75]
    v_mov_b64 v[74:75], s[74:75]
    v_mov_b64 v[76:77], s[74:75]
    v_mov_b64 v[78:79], s[74:75]
    v_mov_b64 v[80:81], s[74:75]
    v_mov_b64 v[82:83], s[74:75]
    s_mov_b64 exec, -1
    v_max3_f32 v2, v96, v97, v98
    v_max3_f32 v2, v2, v99, v100
    v_max3_f32 v2, v2, v101, v102
    v_max3_f32 v2, v2, v103, v104
    v_max3_f32 v2, v2, v105, v106
    v_max3_f32 v2, v2, v107, v108
    v_max3_f32 v2, v2, v109, v110
    v_max3_f32 v2, v2, v111, v140
    v_max3_f32 v2, v2, v141, v142
    v_max_f32 v2, v2, v143
    v_mov_b32 v3, v2
    s_nop 1
    v_permlane32_swap_b32 v3, v2
    s_nop 1
    v_max_f32 v2, v2, v3
    v_mul_f32 v2, s87, v2
    v_fma_f32 v96, v96, s87, -v2
    v_fma_f32 v97, v97, s87, -v2
    v_fma_f32 v98, v98, s87, -v2
    v_fma_f32 v99, v99, s87, -v2
    v_fma_f32 v100, v100, s87, -v2
    v_fma_f32 v101, v101, s87, -v2
    v_fma_f32 v102, v102, s87, -v2
    v_fma_f32 v103, v103, s87, -v2
    v_fma_f32 v104, v104, s87, -v2
    v_fma_f32 v105, v105, s87, -v2
    v_fma_f32 v106, v106, s87, -v2
    v_fma_f32 v107, v107, s87, -v2
    v_fma_f32 v108, v108, s87, -v2
    v_fma_f32 v109, v109, s87, -v2
    v_fma_f32 v110, v110, s87, -v2
    v_fma_f32 v111, v111, s87, -v2
    v_fma_f32 v140, v140, s87, -v2
    v_fma_f32 v141, v141, s87, -v2
    v_fma_f32 v142, v142, s87, -v2
    v_fma_f32 v143, v143, s87, -v2
    v_mov_b64 v[136:137], 0
    v_mov_b64 v[138:139], 0
    v_exp_f32 v96, v96
    v_exp_f32 v97, v97
    v_exp_f32 v98, v98
    v_exp_f32 v99, v99
    v_exp_f32 v100, v100
    v_exp_f32 v101, v101
    v_exp_f32 v102, v102
    v_exp_f32 v103, v103
    v_exp_f32 v104, v104
    v_exp_f32 v105, v105
    v_exp_f32 v106, v106
    v_exp_f32 v107, v107
    v_exp_f32 v108, v108
    v_exp_f32 v109, v109
    v_exp_f32 v110, v110
    v_exp_f32 v111, v111
    v_exp_f32 v140, v140
    v_exp_f32 v141, v141
    v_exp_f32 v142, v142
    v_exp_f32 v143, v143
    s_nop 1
    v_smfmac_f32_32x32x32_bf16 v[192:207], v[60:63], v[96:103], v241
    v_smfmac_f32_32x32x32_bf16 v[192:207], v[64:67], v[104:111], v241
    v_smfmac_f32_32x32x32_bf16 v[192:207], v[68:71], v[136:143], v241
    v_max3_f32 v2, v112, v113, v114
    v_max3_f32 v2, v2, v115, v116
    v_max3_f32 v2, v2, v117, v118
    v_max3_f32 v2, v2, v119, v120
    v_max3_f32 v2, v2, v121, v122
    v_max3_f32 v2, v2, v123, v124
    v_max3_f32 v2, v2, v125, v126
    v_max3_f32 v2, v2, v127, v156
    v_max3_f32 v2, v2, v157, v158
    v_max_f32 v2, v2, v159
    v_mov_b32 v3, v2
    s_nop 1
    v_permlane32_swap_b32 v3, v2
    s_nop 1
    v_max_f32 v2, v2, v3
    v_mul_f32 v2, s87, v2
    v_fma_f32 v112, v112, s87, -v2
    v_fma_f32 v113, v113, s87, -v2
    v_fma_f32 v114, v114, s87, -v2
    v_fma_f32 v115, v115, s87, -v2
    v_fma_f32 v116, v116, s87, -v2
    v_fma_f32 v117, v117, s87, -v2
    v_fma_f32 v118, v118, s87, -v2
    v_fma_f32 v119, v119, s87, -v2
    v_fma_f32 v120, v120, s87, -v2
    v_fma_f32 v121, v121, s87, -v2
    v_fma_f32 v122, v122, s87, -v2
    v_fma_f32 v123, v123, s87, -v2
    v_fma_f32 v124, v124, s87, -v2
    v_fma_f32 v125, v125, s87, -v2
    v_fma_f32 v126, v126, s87, -v2
    v_fma_f32 v127, v127, s87, -v2
    v_fma_f32 v156, v156, s87, -v2
    v_fma_f32 v157, v157, s87, -v2
    v_fma_f32 v158, v158, s87, -v2
    v_fma_f32 v159, v159, s87, -v2
    v_mov_b64 v[152:153], 0
    v_mov_b64 v[154:155], 0
    v_exp_f32 v112, v112
    v_exp_f32 v113, v113
    v_exp_f32 v114, v114
    v_exp_f32 v115, v115
    v_exp_f32 v116, v116
    v_exp_f32 v117, v117
    v_exp_f32 v118, v118
    v_exp_f32 v119, v119
    v_exp_f32 v120, v120
    v_exp_f32 v121, v121
    v_exp_f32 v122, v122
    v_exp_f32 v123, v123
    v_exp_f32 v124, v124
    v_exp_f32 v125, v125
    v_exp_f32 v126, v126
    v_exp_f32 v127, v127
    v_exp_f32 v156, v156
    v_exp_f32 v157, v157
    v_exp_f32 v158, v158
    v_exp_f32 v159, v159
    s_nop 1
    v_smfmac_f32_32x32x32_bf16 v[208:223], v[72:75], v[112:119], v241
    v_smfmac_f32_32x32x32_bf16 v[208:223], v[76:79], v[120:127], v241
    v_smfmac_f32_32x32x32_bf16 v[208:223], v[80:83], v[152:159], v241
    s_mov_b32 m0, s71
    s_add_u32 s59, s69, 0
    buffer_load_dwordx4 v228, s[48:51], s59 offen offset:0 lds
    buffer_load_dwordx4 v229, s[48:51], s59 offen offset:1024 lds
    buffer_load_dwordx4 v230, s[48:51], s59 offen offset:2048 lds
    buffer_load_dwordx4 v231, s[48:51], s59 offen offset:3072 lds
    s_add_u32 m0, s71, 4096
    s_nop 0
    buffer_load_dwordx4 v232, s[48:51], s59 offen offset:0 lds
    buffer_load_dwordx4 v233, s[48:51], s59 offen offset:1024 lds
    s_mov_b64 exec, 0xffff
    buffer_load_dwordx4 v234, s[48:51], s59 offen offset:2048 lds
    s_mov_b64 exec, -1
    v_rcp_f32 v2, v204
    v_rcp_f32 v3, v220
    s_nop 0
    v_mul_f32 v2, v2, v243
    v_mul_f32 v3, v3, v243
    v_pk_mul_f32 v[192:193], v[192:193], v[2:3] op_sel:[0,0] op_sel_hi:[1,0]
    v_pk_mul_f32 v[194:195], v[194:195], v[2:3] op_sel:[0,0] op_sel_hi:[1,0]
    v_pk_mul_f32 v[196:197], v[196:197], v[2:3] op_sel:[0,0] op_sel_hi:[1,0]
    v_pk_mul_f32 v[198:199], v[198:199], v[2:3] op_sel:[0,0] op_sel_hi:[1,0]
    v_pk_mul_f32 v[200:201], v[200:201], v[2:3] op_sel:[0,0] op_sel_hi:[1,0]
    v_pk_mul_f32 v[202:203], v[202:203], v[2:3] op_sel:[0,0] op_sel_hi:[1,0]
    v_cvt_pk_bf16_f32 v24, v192, v193
    v_cvt_pk_bf16_f32 v25, v194, v195
    v_cvt_pk_bf16_f32 v26, v196, v197
    v_cvt_pk_bf16_f32 v27, v198, v199
    v_cvt_pk_bf16_f32 v28, v200, v201
    v_cvt_pk_bf16_f32 v29, v202, v203
    buffer_store_dwordx4 v[24:27], v14, s[36:39], s70 offen offset:0 sc1
    s_mov_b32 exec_hi, 0
    buffer_store_dwordx2 v[28:29], v17, s[36:39], s70 offen offset:2048 sc1
    s_mov_b32 exec_hi, -1
    v_pk_mul_f32 v[208:209], v[208:209], v[2:3] op_sel:[0,1] op_sel_hi:[1,1]
    v_pk_mul_f32 v[210:211], v[210:211], v[2:3] op_sel:[0,1] op_sel_hi:[1,1]
    v_pk_mul_f32 v[212:213], v[212:213], v[2:3] op_sel:[0,1] op_sel_hi:[1,1]
    v_pk_mul_f32 v[214:215], v[214:215], v[2:3] op_sel:[0,1] op_sel_hi:[1,1]
    v_pk_mul_f32 v[216:217], v[216:217], v[2:3] op_sel:[0,1] op_sel_hi:[1,1]
    v_pk_mul_f32 v[218:219], v[218:219], v[2:3] op_sel:[0,1] op_sel_hi:[1,1]
    v_cvt_pk_bf16_f32 v30, v208, v209
    v_cvt_pk_bf16_f32 v31, v210, v211
    v_cvt_pk_bf16_f32 v32, v212, v213
    v_cvt_pk_bf16_f32 v33, v214, v215
    v_cvt_pk_bf16_f32 v34, v216, v217
    v_cvt_pk_bf16_f32 v35, v218, v219
    buffer_store_dwordx4 v[30:33], v14, s[36:39], s70 offen offset:1024 sc1
    s_mov_b32 exec_hi, 0
    buffer_store_dwordx2 v[34:35], v17, s[36:39], s70 offen offset:2304 sc1
    s_mov_b32 exec_hi, -1
    s_mov_b32 s86, 0
LW_B1:
    ds_read_b32 v2, v15 offset:48
    s_add_u32 s86, s86, 1
    s_waitcnt lgkmcnt(0)
    v_readfirstlane_b32 s64, v2
    s_cmp_gt_u32 s86, 1600000
    s_cbranch_scc1 LWD_B1
    s_cmp_ge_u32 s64, 4
    s_cbranch_scc1 LWD_B1
    s_sleep 4
    s_branch LW_B1
LWD_B1:
    s_lshl_b32 s59, s53, 10
    s_add_u32 s60, s59, s78
    s_add_u32 s60, s60, 14809088
    s_add_u32 s59, s59, 0
KV_3:
    s_cmp_ge_u32 s60, 14852096
    s_cselect_b32 s61, 172032, 0
    s_mov_b32 m0, s59
    s_sub_u32 s60, s60, s61
    s_add_u32 s59, s59, 4096
    buffer_load_dwordx4 v14, s[36:39], s60 offen sc1 lds
    s_add_u32 s60, s60, 4096
    s_cmp_lt_u32 s59, 43008
    s_cbranch_scc1 KV_3
    s_add_u32 s59, s63, 14958592
    s_waitcnt vmcnt(10)
    v_mov_b32 v2, 0
    v_mov_b32 v3, s58
    s_mov_b64 exec, 1
    buffer_store_dword v3, v2, s[36:39], s59 offen sc1
    s_mov_b64 exec, -1
    s_waitcnt vmcnt(1)
    s_mov_b64 exec, 1
    ds_add_u32 v15, v16 offset:24
    s_mov_b64 exec, -1
    v_and_b32 v2, 15, v1
    v_lshlrev_b32 v2, 2, v2
    s_mov_b32 s86, 0
PF_OA:
    buffer_load_dword v18, v2, s[36:39], s68 offen offset:0 sc1
    s_add_u32 s86, s86, 1
    s_cmp_gt_u32 s86, 200000
    s_cbranch_scc1 PFD_OA
    s_waitcnt vmcnt(0)
    v_xor_b32 v18, s58, v18
    v_cmp_ne_u32 vcc, 0, v18
    s_nop 4
    s_cbranch_vccz PFD_OA
    s_sleep 8
    s_branch PF_OA
PFD_OA:
    s_add_u32 s59, s90, 0
    buffer_load_dwordx4 v[72:75], v14, s[36:39], s59 offen sc1
    buffer_load_dwordx4 v[76:79], v14, s[36:39], s59 offen offset:1024 sc1
    buffer_load_dwordx2 v[88:89], v17, s[36:39], s59 offen offset:2048 sc1
    s_add_u32 s59, s90, 2560
    buffer_load_dwordx4 v[80:83], v14, s[36:39], s59 offen sc1
    buffer_load_dwordx4 v[84:87], v14, s[36:39], s59 offen offset:1024 sc1
    buffer_load_dwordx2 v[90:91], v17, s[36:39], s59 offen offset:2048 sc1
    s_add_u32 s59, s90, 5120
    buffer_load_dwordx4 v[92:95], v14, s[36:39], s59 offen sc1
    buffer_load_dwordx4 v[96:99], v14, s[36:39], s59 offen offset:1024 sc1
    buffer_load_dwordx2 v[108:109], v17, s[36:39], s59 offen offset:2048 sc1
    s_add_u32 s59, s90, 7680
    buffer_load_dwordx4 v[100:103], v14, s[36:39], s59 offen sc1
    buffer_load_dwordx4 v[104:107], v14, s[36:39], s59 offen offset:1024 sc1
    buffer_load_dwordx2 v[110:111], v17, s[36:39], s59 offen offset:2048 sc1
    s_add_u32 s59, s90, 10240
    buffer_load_dwordx4 v[112:115], v14, s[36:39], s59 offen sc1
    buffer_load_dwordx4 v[116:119], v14, s[36:39], s59 offen offset:1024 sc1
    buffer_load_dwordx2 v[128:129], v17, s[36:39], s59 offen offset:2048 sc1
    s_add_u32 s59, s90, 12800
    buffer_load_dwordx4 v[120:123], v14, s[36:39], s59 offen sc1
    buffer_load_dwordx4 v[124:127], v14, s[36:39], s59 offen offset:1024 sc1
    buffer_load_dwordx2 v[130:131], v17, s[36:39], s59 offen offset:2048 sc1
    s_add_u32 s59, s90, 15360
    buffer_load_dwordx4 v[132:135], v14, s[36:39], s59 offen sc1
    buffer_load_dwordx4 v[136:139], v14, s[36:39], s59 offen offset:1024 sc1
    buffer_load_dwordx2 v[148:149], v17, s[36:39], s59 offen offset:2048 sc1
    s_add_u32 s59, s90, 17920
    buffer_load_dwordx4 v[140:143], v14, s[36:39], s59 offen sc1
    buffer_load_dwordx4 v[144:147], v14, s[36:39], s59 offen offset:1024 sc1
    buffer_load_dwordx2 v[150:151], v17, s[36:39], s59 offen offset:2048 sc1
    s_waitcnt vmcnt(0)
    ds_read_b64_tr_b16 v[152:153], v224 offset:0
    ds_read_b64_tr_b16 v[154:155], v224 offset:1280
    ds_read_b64_tr_b16 v[156:157], v224 offset:64
    ds_read_b64_tr_b16 v[158:159], v224 offset:1344
    ds_read_b64_tr_b16 v[160:161], v225 offset:0
    ds_read_b64_tr_b16 v[162:163], v225 offset:1280
    ds_read_b64_tr_b16 v[164:165], v224 offset:3200
    ds_read_b64_tr_b16 v[166:167], v224 offset:4480
    ds_read_b64_tr_b16 v[168:169], v224 offset:3264
    ds_read_b64_tr_b16 v[170:171], v224 offset:4544
    ds_read_b64_tr_b16 v[172:173], v225 offset:3200
    ds_read_b64_tr_b16 v[174:175], v225 offset:4480
    ds_read_b64_tr_b16 v[200:201], v226 offset:0
    ds_read_b64_tr_b16 v[204:205], v226 offset:64
    ds_read_b64_tr_b16 v[208:209], v227 offset:0
    s_waitcnt lgkmcnt(0)
    s_mov_b32 m0, s71
    s_add_u32 s59, s69, 51200
    buffer_load_dwordx4 v228, s[48:51], s59 offen offset:0 lds
    buffer_load_dwordx4 v229, s[48:51], s59 offen offset:1024 lds
    buffer_load_dwordx4 v230, s[48:51], s59 offen offset:2048 lds
    buffer_load_dwordx4 v231, s[48:51], s59 offen offset:3072 lds
    s_add_u32 m0, s71, 4096
    s_nop 0
    buffer_load_dwordx4 v232, s[48:51], s59 offen offset:0 lds
    buffer_load_dwordx4 v233, s[48:51], s59 offen offset:1024 lds
    s_mov_b64 exec, 0xffff
    buffer_load_dwordx4 v234, s[48:51], s59 offen offset:2048 lds
    s_mov_b64 exec, -1
    s_setprio 0
    v_mfma_f32_32x32x16_bf16 v[24:39], v[152:155], v[72:75], 0
    v_mfma_f32_32x32x16_bf16 v[40:55], v[156:159], v[72:75], 0
    v_mfma_f32_32x32x16_bf16 v[56:71], v[160:163], v[72:75], 0
    v_mfma_f32_32x32x16_bf16 v[24:39], v[164:167], v[76:79], v[24:39]
    v_mfma_f32_32x32x16_bf16 v[40:55], v[168:171], v[76:79], v[40:55]
    v_mfma_f32_32x32x16_bf16 v[56:71], v[172:175], v[76:79], v[56:71]
    s_setprio 3
    s_waitcnt vmcnt(0)
    ds_read_b64_tr_b16 v[176:177], v224 offset:0
    ds_read_b64_tr_b16 v[178:179], v224 offset:1280
    ds_read_b64_tr_b16 v[180:181], v224 offset:64
    ds_read_b64_tr_b16 v[182:183], v224 offset:1344
    ds_read_b64_tr_b16 v[184:185], v225 offset:0
    ds_read_b64_tr_b16 v[186:187], v225 offset:1280
    ds_read_b64_tr_b16 v[188:189], v224 offset:3200
    ds_read_b64_tr_b16 v[190:191], v224 offset:4480
    ds_read_b64_tr_b16 v[192:193], v224 offset:3264
    ds_read_b64_tr_b16 v[194:195], v224 offset:4544
    ds_read_b64_tr_b16 v[196:197], v225 offset:3200
    ds_read_b64_tr_b16 v[198:199], v225 offset:4480
    ds_read_b64_tr_b16 v[202:203], v226 offset:0
    ds_read_b64_tr_b16 v[206:207], v226 offset:64
    ds_read_b64_tr_b16 v[210:211], v227 offset:0
    s_waitcnt lgkmcnt(0)
    s_mov_b32 m0, s71
    s_add_u32 s59, s69, 102400
    buffer_load_dwordx4 v228, s[48:51], s59 offen offset:0 lds
    buffer_load_dwordx4 v229, s[48:51], s59 offen offset:1024 lds
    buffer_load_dwordx4 v230, s[48:51], s59 offen offset:2048 lds
    buffer_load_dwordx4 v231, s[48:51], s59 offen offset:3072 lds
    s_add_u32 m0, s71, 4096
    s_nop 0
    buffer_load_dwordx4 v232, s[48:51], s59 offen offset:0 lds
    buffer_load_dwordx4 v233, s[48:51], s59 offen offset:1024 lds
    s_mov_b64 exec, 0xffff
    buffer_load_dwordx4 v234, s[48:51], s59 offen offset:2048 lds
    s_mov_b64 exec, -1
    s_setprio 0
    v_mfma_f32_32x32x16_bf16 v[24:39], v[176:179], v[80:83], v[24:39]
    v_mfma_f32_32x32x16_bf16 v[40:55], v[180:183], v[80:83], v[40:55]
    v_mfma_f32_32x32x16_bf16 v[56:71], v[184:187], v[80:83], v[56:71]
    v_mfma_f32_32x32x16_bf16 v[24:39], v[188:191], v[84:87], v[24:39]
    v_mfma_f32_32x32x16_bf16 v[40:55], v[192:195], v[84:87], v[40:55]
    v_mfma_f32_32x32x16_bf16 v[56:71], v[196:199], v[84:87], v[56:71]
    v_mfma_f32_32x32x16_bf16 v[24:39], v[200:203], v[88:91], v[24:39]
    v_mfma_f32_32x32x16_bf16 v[40:55], v[204:207], v[88:91], v[40:55]
    v_mfma_f32_32x32x16_bf16 v[56:71], v[208:211], v[88:91], v[56:71]
    s_setprio 3
    s_waitcnt vmcnt(0)
    ds_read_b64_tr_b16 v[152:153], v224 offset:0
    ds_read_b64_tr_b16 v[154:155], v224 offset:1280
    ds_read_b64_tr_b16 v[156:157], v224 offset:64
    ds_read_b64_tr_b16 v[158:159], v224 offset:1344
    ds_read_b64_tr_b16 v[160:161], v225 offset:0
    ds_read_b64_tr_b16 v[162:163], v225 offset:1280
    ds_read_b64_tr_b16 v[164:165], v224 offset:3200
    ds_read_b64_tr_b16 v[166:167], v224 offset:4480
    ds_read_b64_tr_b16 v[168:169], v224 offset:3264
    ds_read_b64_tr_b16 v[170:171], v224 offset:4544
    ds_read_b64_tr_b16 v[172:173], v225 offset:3200
    ds_read_b64_tr_b16 v[174:175], v225 offset:4480
    ds_read_b64_tr_b16 v[212:213], v226 offset:0
    ds_read_b64_tr_b16 v[216:217], v226 offset:64
    ds_read_b64_tr_b16 v[220:221], v227 offset:0
    s_waitcnt lgkmcnt(0)
    s_mov_b32 m0, s71
    s_add_u32 s59, s69, 153600
    buffer_load_dwordx4 v228, s[48:51], s59 offen offset:0 lds
    buffer_load_dwordx4 v229, s[48:51], s59 offen offset:1024 lds
    buffer_load_dwordx4 v230, s[48:51], s59 offen offset:2048 lds
    buffer_load_dwordx4 v231, s[48:51], s59 offen offset:3072 lds
    s_add_u32 m0, s71, 4096
    s_nop 0
    buffer_load_dwordx4 v232, s[48:51], s59 offen offset:0 lds
    buffer_load_dwordx4 v233, s[48:51], s59 offen offset:1024 lds
    s_mov_b64 exec, 0xffff
    buffer_load_dwordx4 v234, s[48:51], s59 offen offset:2048 lds
    s_mov_b64 exec, -1
    s_setprio 0
    v_mfma_f32_32x32x16_bf16 v[24:39], v[152:155], v[92:95], v[24:39]
    v_mfma_f32_32x32x16_bf16 v[40:55], v[156:159], v[92:95], v[40:55]
    v_mfma_f32_32x32x16_bf16 v[56:71], v[160:163], v[92:95], v[56:71]
    v_mfma_f32_32x32x16_bf16 v[24:39], v[164:167], v[96:99], v[24:39]
    v_mfma_f32_32x32x16_bf16 v[40:55], v[168:171], v[96:99], v[40:55]
    v_mfma_f32_32x32x16_bf16 v[56:71], v[172:175], v[96:99], v[56:71]
    s_setprio 3
    s_waitcnt vmcnt(0)
    ds_read_b64_tr_b16 v[176:177], v224 offset:0
    ds_read_b64_tr_b16 v[178:179], v224 offset:1280
    ds_read_b64_tr_b16 v[180:181], v224 offset:64
    ds_read_b64_tr_b16 v[182:183], v224 offset:1344
    ds_read_b64_tr_b16 v[184:185], v225 offset:0
    ds_read_b64_tr_b16 v[186:187], v225 offset:1280
    ds_read_b64_tr_b16 v[188:189], v224 offset:3200
    ds_read_b64_tr_b16 v[190:191], v224 offset:4480
    ds_read_b64_tr_b16 v[192:193], v224 offset:3264
    ds_read_b64_tr_b16 v[194:195], v224 offset:4544
    ds_read_b64_tr_b16 v[196:197], v225 offset:3200
    ds_read_b64_tr_b16 v[198:199], v225 offset:4480
    ds_read_b64_tr_b16 v[214:215], v226 offset:0
    ds_read_b64_tr_b16 v[218:219], v226 offset:64
    ds_read_b64_tr_b16 v[222:223], v227 offset:0
    s_waitcnt lgkmcnt(0)
    s_mov_b32 m0, s71
    s_add_u32 s59, s69, 204800
    buffer_load_dwordx4 v228, s[48:51], s59 offen offset:0 lds
    buffer_load_dwordx4 v229, s[48:51], s59 offen offset:1024 lds
    buffer_load_dwordx4 v230, s[48:51], s59 offen offset:2048 lds
    buffer_load_dwordx4 v231, s[48:51], s59 offen offset:3072 lds
    s_add_u32 m0, s71, 4096
    s_nop 0
    buffer_load_dwordx4 v232, s[48:51], s59 offen offset:0 lds
    buffer_load_dwordx4 v233, s[48:51], s59 offen offset:1024 lds
    s_mov_b64 exec, 0xffff
    buffer_load_dwordx4 v234, s[48:51], s59 offen offset:2048 lds
    s_mov_b64 exec, -1
    s_mov_b32 s86, 0
LW_B1b:
    ds_read_b32 v2, v15 offset:52
    s_add_u32 s86, s86, 1
    s_waitcnt lgkmcnt(0)
    v_readfirstlane_b32 s64, v2
    s_cmp_gt_u32 s86, 1600000
    s_cbranch_scc1 LWD_B1b
    s_cmp_ge_u32 s64, 4
    s_cbranch_scc1 LWD_B1b
    s_sleep 4
    s_branch LW_B1b
LWD_B1b:
    s_mul_i32 s61, s53, 2
    s_add_u32 s61, s61, 0
    s_mul_i32 s59, s61, 40960
    s_and_b32 s60, s55, 7
    s_mul_i32 s60, s60, 160
    s_add_u32 s59, s59, s60
    s_mul_i32 s60, s61, 5120
    s_add_u32 s60, s60, 43008
    s_add_u32 s61, s60, 10240
GB_WOB1:
    s_mov_b32 m0, s60
    s_nop 0
    buffer_load_dwordx4 v228, s[32:35], s59 offen offset:0 lds
    buffer_load_dwordx4 v229, s[32:35], s59 offen offset:1024 lds
    buffer_load_dwordx4 v230, s[32:35], s59 offen offset:2048 lds
    buffer_load_dwordx4 v231, s[32:35], s59 offen offset:3072 lds
    s_add_u32 m0, s60, 4096
    s_add_u32 s60, s60, 5120
    buffer_load_dwordx4 v232, s[32:35], s59 offen lds
    s_add_u32 s59, s59, 40960
    s_cmp_lt_u32 s60, s61
    s_cbranch_scc1 GB_WOB1
    s_setprio 0
    v_mfma_f32_32x32x16_bf16 v[24:39], v[176:179], v[100:103], v[24:39]
    v_mfma_f32_32x32x16_bf16 v[40:55], v[180:183], v[100:103], v[40:55]
    v_mfma_f32_32x32x16_bf16 v[56:71], v[184:187], v[100:103], v[56:71]
    v_mfma_f32_32x32x16_bf16 v[24:39], v[188:191], v[104:107], v[24:39]
    v_mfma_f32_32x32x16_bf16 v[40:55], v[192:195], v[104:107], v[40:55]
    v_mfma_f32_32x32x16_bf16 v[56:71], v[196:199], v[104:107], v[56:71]
    v_mfma_f32_32x32x16_bf16 v[24:39], v[212:215], v[108:111], v[24:39]
    v_mfma_f32_32x32x16_bf16 v[40:55], v[216:219], v[108:111], v[40:55]
    v_mfma_f32_32x32x16_bf16 v[56:71], v[220:223], v[108:111], v[56:71]
    s_setprio 3
    s_waitcnt vmcnt(0)
    ds_read_b64_tr_b16 v[152:153], v224 offset:0
    ds_read_b64_tr_b16 v[154:155], v224 offset:1280
    ds_read_b64_tr_b16 v[156:157], v224 offset:64
    ds_read_b64_tr_b16 v[158:159], v224 offset:1344
    ds_read_b64_tr_b16 v[160:161], v225 offset:0
    ds_read_b64_tr_b16 v[162:163], v225 offset:1280
    ds_read_b64_tr_b16 v[164:165], v224 offset:3200
    ds_read_b64_tr_b16 v[166:167], v224 offset:4480
    ds_read_b64_tr_b16 v[168:169], v224 offset:3264
    ds_read_b64_tr_b16 v[170:171], v224 offset:4544
    ds_read_b64_tr_b16 v[172:173], v225 offset:3200
    ds_read_b64_tr_b16 v[174:175], v225 offset:4480
    ds_read_b64_tr_b16 v[200:201], v226 offset:0
    ds_read_b64_tr_b16 v[204:205], v226 offset:64
    ds_read_b64_tr_b16 v[208:209], v227 offset:0
    s_waitcnt lgkmcnt(0)
    s_mov_b32 m0, s71
    s_add_u32 s59, s69, 256000
    buffer_load_dwordx4 v228, s[48:51], s59 offen offset:0 lds
    buffer_load_dwordx4 v229, s[48:51], s59 offen offset:1024 lds
    buffer_load_dwordx4 v230, s[48:51], s59 offen offset:2048 lds
    buffer_load_dwordx4 v231, s[48:51], s59 offen offset:3072 lds
    s_add_u32 m0, s71, 4096
    s_nop 0
    buffer_load_dwordx4 v232, s[48:51], s59 offen offset:0 lds
    buffer_load_dwordx4 v233, s[48:51], s59 offen offset:1024 lds
    s_mov_b64 exec, 0xffff
    buffer_load_dwordx4 v234, s[48:51], s59 offen offset:2048 lds
    s_mov_b64 exec, -1
    s_setprio 0
    v_mfma_f32_32x32x16_bf16 v[24:39], v[152:155], v[112:115], v[24:39]
    v_mfma_f32_32x32x16_bf16 v[40:55], v[156:159], v[112:115], v[40:55]
    v_mfma_f32_32x32x16_bf16 v[56:71], v[160:163], v[112:115], v[56:71]
    v_mfma_f32_32x32x16_bf16 v[24:39], v[164:167], v[116:119], v[24:39]
    v_mfma_f32_32x32x16_bf16 v[40:55], v[168:171], v[116:119], v[40:55]
    v_mfma_f32_32x32x16_bf16 v[56:71], v[172:175], v[116:119], v[56:71]
    s_setprio 3
    s_waitcnt vmcnt(0)
    ds_read_b64_tr_b16 v[176:177], v224 offset:0
    ds_read_b64_tr_b16 v[178:179], v224 offset:1280
    ds_read_b64_tr_b16 v[180:181], v224 offset:64
    ds_read_b64_tr_b16 v[182:183], v224 offset:1344
    ds_read_b64_tr_b16 v[184:185], v225 offset:0
    ds_read_b64_tr_b16 v[186:187], v225 offset:1280
    ds_read_b64_tr_b16 v[188:189], v224 offset:3200
    ds_read_b64_tr_b16 v[190:191], v224 offset:4480
    ds_read_b64_tr_b16 v[192:193], v224 offset:3264
    ds_read_b64_tr_b16 v[194:195], v224 offset:4544
    ds_read_b64_tr_b16 v[196:197], v225 offset:3200
    ds_read_b64_tr_b16 v[198:199], v225 offset:4480
    ds_read_b64_tr_b16 v[202:203], v226 offset:0
    ds_read_b64_tr_b16 v[206:207], v226 offset:64
    ds_read_b64_tr_b16 v[210:211], v227 offset:0
    s_waitcnt lgkmcnt(0)
    s_mov_b32 m0, s71
    s_add_u32 s59, s69, 307200
    buffer_load_dwordx4 v228, s[48:51], s59 offen offset:0 lds
    buffer_load_dwordx4 v229, s[48:51], s59 offen offset:1024 lds
    buffer_load_dwordx4 v230, s[48:51], s59 offen offset:2048 lds
    buffer_load_dwordx4 v231, s[48:51], s59 offen offset:3072 lds
    s_add_u32 m0, s71, 4096
    s_nop 0
    buffer_load_dwordx4 v232, s[48:51], s59 offen offset:0 lds
    buffer_load_dwordx4 v233, s[48:51], s59 offen offset:1024 lds
    s_mov_b64 exec, 0xffff
    buffer_load_dwordx4 v234, s[48:51], s59 offen offset:2048 lds
    s_mov_b64 exec, -1
    s_setprio 0
    v_mfma_f32_32x32x16_bf16 v[24:39], v[176:179], v[120:123], v[24:39]
    v_mfma_f32_32x32x16_bf16 v[40:55], v[180:183], v[120:123], v[40:55]
    v_mfma_f32_32x32x16_bf16 v[56:71], v[184:187], v[120:123], v[56:71]
    v_mfma_f32_32x32x16_bf16 v[24:39], v[188:191], v[124:127], v[24:39]
    v_mfma_f32_32x32x16_bf16 v[40:55], v[192:195], v[124:127], v[40:55]
    v_mfma_f32_32x32x16_bf16 v[56:71], v[196:199], v[124:127], v[56:71]
    v_mfma_f32_32x32x16_bf16 v[24:39], v[200:203], v[128:131], v[24:39]
    v_mfma_f32_32x32x16_bf16 v[40:55], v[204:207], v[128:131], v[40:55]
    v_mfma_f32_32x32x16_bf16 v[56:71], v[208:211], v[128:131], v[56:71]
    s_setprio 3
    s_waitcnt vmcnt(0)
    ds_read_b64_tr_b16 v[152:153], v224 offset:0
    ds_read_b64_tr_b16 v[154:155], v224 offset:1280
    ds_read_b64_tr_b16 v[156:157], v224 offset:64
    ds_read_b64_tr_b16 v[158:159], v224 offset:1344
    ds_read_b64_tr_b16 v[160:161], v225 offset:0
    ds_read_b64_tr_b16 v[162:163], v225 offset:1280
    ds_read_b64_tr_b16 v[164:165], v224 offset:3200
    ds_read_b64_tr_b16 v[166:167], v224 offset:4480
    ds_read_b64_tr_b16 v[168:169], v224 offset:3264
    ds_read_b64_tr_b16 v[170:171], v224 offset:4544
    ds_read_b64_tr_b16 v[172:173], v225 offset:3200
    ds_read_b64_tr_b16 v[174:175], v225 offset:4480
    ds_read_b64_tr_b16 v[212:213], v226 offset:0
    ds_read_b64_tr_b16 v[216:217], v226 offset:64
    ds_read_b64_tr_b16 v[220:221], v227 offset:0
    s_waitcnt lgkmcnt(0)
    s_mov_b32 m0, s71
    s_add_u32 s59, s69, 358400
    buffer_load_dwordx4 v228, s[48:51], s59 offen offset:0 lds
    buffer_load_dwordx4 v229, s[48:51], s59 offen offset:1024 lds
    buffer_load_dwordx4 v230, s[48:51], s59 offen offset:2048 lds
    buffer_load_dwordx4 v231, s[48:51], s59 offen offset:3072 lds
    s_add_u32 m0, s71, 4096
    s_nop 0
    buffer_load_dwordx4 v232, s[48:51], s59 offen offset:0 lds
    buffer_load_dwordx4 v233, s[48:51], s59 offen offset:1024 lds
    s_mov_b64 exec, 0xffff
    buffer_load_dwordx4 v234, s[48:51], s59 offen offset:2048 lds
    s_mov_b64 exec, -1
    s_setprio 0
    v_mfma_f32_32x32x16_bf16 v[24:39], v[152:155], v[132:135], v[24:39]
    v_mfma_f32_32x32x16_bf16 v[40:55], v[156:159], v[132:135], v[40:55]
    v_mfma_f32_32x32x16_bf16 v[56:71], v[160:163], v[132:135], v[56:71]
    v_mfma_f32_32x32x16_bf16 v[24:39], v[164:167], v[136:139], v[24:39]
    v_mfma_f32_32x32x16_bf16 v[40:55], v[168:171], v[136:139], v[40:55]
    v_mfma_f32_32x32x16_bf16 v[56:71], v[172:175], v[136:139], v[56:71]
    s_setprio 3
    s_waitcnt vmcnt(0)
    ds_read_b64_tr_b16 v[176:177], v224 offset:0
    ds_read_b64_tr_b16 v[178:179], v224 offset:1280
    ds_read_b64_tr_b16 v[180:181], v224 offset:64
    ds_read_b64_tr_b16 v[182:183], v224 offset:1344
    ds_read_b64_tr_b16 v[184:185], v225 offset:0
    ds_read_b64_tr_b16 v[186:187], v225 offset:1280
    ds_read_b64_tr_b16 v[188:189], v224 offset:3200
    ds_read_b64_tr_b16 v[190:191], v224 offset:4480
    ds_read_b64_tr_b16 v[192:193], v224 offset:3264
    ds_read_b64_tr_b16 v[194:195], v224 offset:4544
    ds_read_b64_tr_b16 v[196:197], v225 offset:3200
    ds_read_b64_tr_b16 v[198:199], v225 offset:4480
    ds_read_b64_tr_b16 v[214:215], v226 offset:0
    ds_read_b64_tr_b16 v[218:219], v226 offset:64
    ds_read_b64_tr_b16 v[222:223], v227 offset:0
    s_waitcnt lgkmcnt(0)
    s_mov_b32 s86, 0
LW_B2:
    ds_read_b32 v2, v15 offset:56
    s_add_u32 s86, s86, 1
    s_waitcnt lgkmcnt(0)
    v_readfirstlane_b32 s64, v2
    s_cmp_gt_u32 s86, 1600000
    s_cbranch_scc1 LWD_B2
    s_cmp_ge_u32 s64, 4
    s_cbranch_scc1 LWD_B2
    s_sleep 8
    s_branch LW_B2
LWD_B2:
    s_mul_i32 s61, s53, 2
    s_add_u32 s61, s61, 8
    s_mul_i32 s59, s61, 40960
    s_and_b32 s60, s55, 7
    s_mul_i32 s60, s60, 160
    s_add_u32 s59, s59, s60
    s_mul_i32 s60, s61, 5120
    s_add_u32 s60, s60, 43008
    s_add_u32 s61, s60, 10240
GB_WOB2:
    s_mov_b32 m0, s60
    s_nop 0
    buffer_load_dwordx4 v228, s[32:35], s59 offen offset:0 lds
    buffer_load_dwordx4 v229, s[32:35], s59 offen offset:1024 lds
    buffer_load_dwordx4 v230, s[32:35], s59 offen offset:2048 lds
    buffer_load_dwordx4 v231, s[32:35], s59 offen offset:3072 lds
    s_add_u32 m0, s60, 4096
    s_add_u32 s60, s60, 5120
    buffer_load_dwordx4 v232, s[32:35], s59 offen lds
    s_add_u32 s59, s59, 40960
    s_cmp_lt_u32 s60, s61
    s_cbranch_scc1 GB_WOB2
    s_setprio 0
    v_mfma_f32_32x32x16_bf16 v[24:39], v[176:179], v[140:143], v[24:39]
    v_mfma_f32_32x32x16_bf16 v[40:55], v[180:183], v[140:143], v[40:55]
    v_mfma_f32_32x32x16_bf16 v[56:71], v[184:187], v[140:143], v[56:71]
    v_mfma_f32_32x32x16_bf16 v[24:39], v[188:191], v[144:147], v[24:39]
    v_mfma_f32_32x32x16_bf16 v[40:55], v[192:195], v[144:147], v[40:55]
    v_mfma_f32_32x32x16_bf16 v[56:71], v[196:199], v[144:147], v[56:71]
    v_mfma_f32_32x32x16_bf16 v[24:39], v[212:215], v[148:151], v[24:39]
    v_mfma_f32_32x32x16_bf16 v[40:55], v[216:219], v[148:151], v[40:55]
    v_mfma_f32_32x32x16_bf16 v[56:71], v[220:223], v[148:151], v[56:71]
    s_setprio 3
    s_lshr_b32 s61, s53, 1
    s_mul_i32 s59, s61, 20480
    s_sub_u32 s90, s90, s59
    s_add_u32 s90, s90, 40960
    s_lshr_b32 s62, s55, 2
    s_add_u32 s59, s62, 1
    s_and_b32 s59, s59, 3
    s_lshl1_add_u32 s59, s59, s61
    s_mul_i32 s60, s59, 5120
    s_add_u32 s40, s90, s60
    s_mul_i32 s60, s59, 12800
    s_add_u32 s60, s60, 43008
    s_sub_u32 s44, s60, s71
    s_add_u32 s59, s62, 2
    s_and_b32 s59, s59, 3
    s_lshl1_add_u32 s59, s59, s61
    s_mul_i32 s60, s59, 5120
    s_add_u32 s41, s90, s60
    s_mul_i32 s60, s59, 12800
    s_add_u32 s60, s60, 43008
    s_sub_u32 s45, s60, s71
    s_add_u32 s59, s62, 3
    s_and_b32 s59, s59, 3
    s_lshl1_add_u32 s59, s59, s61
    s_mul_i32 s60, s59, 5120
    s_add_u32 s42, s90, s60
    s_mul_i32 s60, s59, 12800
    s_add_u32 s60, s60, 43008
    s_sub_u32 s46, s60, s71
    s_add_u32 s59, s62, 4
    s_and_b32 s59, s59, 3
    s_lshl1_add_u32 s59, s59, s61
    s_mul_i32 s60, s59, 5120
    s_add_u32 s43, s90, s60
    s_mul_i32 s60, s59, 12800
    s_add_u32 s60, s60, 43008
    s_sub_u32 s47, s60, s71
    s_mov_b64 exec, 1
    ds_add_u32 v15, v16 offset:28
    s_mov_b64 exec, -1
    s_mov_b32 s86, 0
LW_B3:
    ds_read_b32 v2, v15 offset:28
    s_add_u32 s86, s86, 1
    s_waitcnt lgkmcnt(0)
    v_readfirstlane_b32 s64, v2
    s_cmp_gt_u32 s86, 1600000
    s_cbranch_scc1 LWD_B3
    s_cmp_ge_u32 s64, 4
    s_cbranch_scc1 LWD_B3
    s_sleep 2
    s_branch LW_B3
LWD_B3:
    s_mul_i32 s61, s53, 1
    s_add_u32 s61, s61, 16
    s_mul_i32 s59, s61, 40960
    s_and_b32 s60, s55, 7
    s_mul_i32 s60, s60, 160
    s_add_u32 s59, s59, s60
    s_mul_i32 s60, s61, 5120
    s_add_u32 s60, s60, 43008
    s_add_u32 s61, s60, 5120
GB_WOB3:
    s_mov_b32 m0, s60
    s_nop 0
    buffer_load_dwordx4 v228, s[32:35], s59 offen offset:0 lds
    buffer_load_dwordx4 v229, s[32:35], s59 offen offset:1024 lds
    buffer_load_dwordx4 v230, s[32:35], s59 offen offset:2048 lds
    buffer_load_dwordx4 v231, s[32:35], s59 offen offset:3072 lds
    s_add_u32 m0, s60, 4096
    s_add_u32 s60, s60, 5120
    buffer_load_dwordx4 v232, s[32:35], s59 offen lds
    s_add_u32 s59, s59, 40960
    s_cmp_lt_u32 s60, s61
    s_cbranch_scc1 GB_WOB3
    s_mov_b32 s28, s22
    s_and_b32 s29, s23, 0xffff
    s_mov_b32 s30, 2621440
    s_mov_b32 s31, 0x00020000
    s_lshr_b32 s59, s55, 3
    s_lshl1_add_u32 s59, s54, s59
    s_mul_i32 s59, s59, 81920
    s_and_b32 s60, s55, 7
    s_mul_i32 s60, s60, 160
    s_add_u32 s78, s59, s60
    s_waitcnt vmcnt(0)
    s_mov_b64 exec, 1
    ds_add_u32 v15, v16 offset:32
    s_mov_b64 exec, -1
    s_mov_b32 s86, 0
LW_B4:
    ds_read_b32 v2, v15 offset:32
    s_add_u32 s86, s86, 1
    s_waitcnt lgkmcnt(0)
    v_readfirstlane_b32 s64, v2
    s_cmp_gt_u32 s86, 1600000
    s_cbranch_scc1 LWD_B4
    s_cmp_ge_u32 s64, 4
    s_cbranch_scc1 LWD_B4
    s_sleep 2
    s_branch LW_B4
LWD_B4:
    s_mov_b32 s86, 0
LW_B5:
    ds_read_b32 v2, v15 offset:64
    s_add_u32 s86, s86, 1
    s_waitcnt lgkmcnt(0)
    v_readfirstlane_b32 s64, v2
    s_cmp_gt_u32 s86, 1600000
    s_cbranch_scc1 LWD_B5
    s_cmp_ge_u32 s64, 4
    s_cbranch_scc1 LWD_B5
    s_sleep 2
    s_branch LW_B5
LWD_B5:
    s_mov_b32 s86, 0
    s_mov_b32 s63, 8
GB_PASS:
    s_bitcmp1_b32 s63, 0
    s_cbranch_scc1 GB_NL0
    s_add_u32 s59, s40, 0
    buffer_load_dwordx4 v[72:75], v14, s[36:39], s59 offen sc1
    buffer_load_dwordx4 v[76:79], v14, s[36:39], s59 offen offset:1024 sc1
    buffer_load_dwordx2 v[88:89], v17, s[36:39], s59 offen offset:2048 sc1
    s_add_u32 s59, s40, 2560
    buffer_load_dwordx4 v[80:83], v14, s[36:39], s59 offen sc1
    buffer_load_dwordx4 v[84:87], v14, s[36:39], s59 offen offset:1024 sc1
    buffer_load_dwordx2 v[90:91], v17, s[36:39], s59 offen offset:2048 sc1
GB_NL0:
    s_bitcmp1_b32 s63, 1
    s_cbranch_scc1 GB_NL1
    s_add_u32 s59, s41, 0
    buffer_load_dwordx4 v[92:95], v14, s[36:39], s59 offen sc1
    buffer_load_dwordx4 v[96:99], v14, s[36:39], s59 offen offset:1024 sc1
    buffer_load_dwordx2 v[108:109], v17, s[36:39], s59 offen offset:2048 sc1
    s_add_u32 s59, s41, 2560
    buffer_load_dwordx4 v[100:103], v14, s[36:39], s59 offen sc1
    buffer_load_dwordx4 v[104:107], v14, s[36:39], s59 offen offset:1024 sc1
    buffer_load_dwordx2 v[110:111], v17, s[36:39], s59 offen offset:2048 sc1
GB_NL1:
    s_bitcmp1_b32 s63, 2
    s_cbranch_scc1 GB_NL2
    s_add_u32 s59, s42, 0
    buffer_load_dwordx4 v[112:115], v14, s[36:39], s59 offen sc1
    buffer_load_dwordx4 v[116:119], v14, s[36:39], s59 offen offset:1024 sc1
    buffer_load_dwordx2 v[128:129], v17, s[36:39], s59 offen offset:2048 sc1
    s_add_u32 s59, s42, 2560
    buffer_load_dwordx4 v[120:123], v14, s[36:39], s59 offen sc1
    buffer_load_dwordx4 v[124:127], v14, s[36:39], s59 offen offset:1024 sc1
    buffer_load_dwordx2 v[130:131], v17, s[36:39], s59 offen offset:2048 sc1
GB_NL2:
    s_bitcmp1_b32 s63, 3
    s_cbranch_scc1 GB_NL3
    s_add_u32 s59, s43, 0
    buffer_load_dwordx4 v[132:135], v14, s[36:39], s59 offen sc1
    buffer_load_dwordx4 v[136:139], v14, s[36:39], s59 offen offset:1024 sc1
    buffer_load_dwordx2 v[148:149], v17, s[36:39], s59 offen offset:2048 sc1
    s_add_u32 s59, s43, 2560
    buffer_load_dwordx4 v[140:143], v14, s[36:39], s59 offen sc1
    buffer_load_dwordx4 v[144:147], v14, s[36:39], s59 offen offset:1024 sc1
    buffer_load_dwordx2 v[150:151], v17, s[36:39], s59 offen offset:2048 sc1
GB_NL3:
    s_add_u32 s86, s86, 1
GB_CHK:
    s_bitcmp1_b32 s63, 0
    s_cbranch_scc1 GB_NP0
    v_add_u32 v4, s44, v224
    v_add_u32 v5, s44, v225
    v_add_u32 v6, s44, v226
    v_add_u32 v7, s44, v227
    ds_read_b64_tr_b16 v[152:153], v4 offset:0
    ds_read_b64_tr_b16 v[154:155], v4 offset:1280
    ds_read_b64_tr_b16 v[156:157], v4 offset:64
    ds_read_b64_tr_b16 v[158:159], v4 offset:1344
    ds_read_b64_tr_b16 v[160:161], v5 offset:0
    ds_read_b64_tr_b16 v[162:163], v5 offset:1280
    ds_read_b64_tr_b16 v[164:165], v4 offset:3200
    ds_read_b64_tr_b16 v[166:167], v4 offset:4480
    ds_read_b64_tr_b16 v[168:169], v4 offset:3264
    ds_read_b64_tr_b16 v[170:171], v4 offset:4544
    ds_read_b64_tr_b16 v[172:173], v5 offset:3200
    ds_read_b64_tr_b16 v[174:175], v5 offset:4480
    ds_read_b64_tr_b16 v[200:201], v6 offset:0
    ds_read_b64_tr_b16 v[204:205], v6 offset:64
    ds_read_b64_tr_b16 v[208:209], v7 offset:0
    s_cmp_eq_u32 s86, 1
    s_cbranch_scc1 GB_W0
    s_waitcnt vmcnt(0)
    s_branch GB_WD
GB_W0:
    s_waitcnt vmcnt(12)
    s_add_u32 s59, s43, 0
    buffer_load_dwordx4 v[132:135], v14, s[36:39], s59 offen sc1
    buffer_load_dwordx4 v[136:139], v14, s[36:39], s59 offen offset:1024 sc1
    buffer_load_dwordx2 v[148:149], v17, s[36:39], s59 offen offset:2048 sc1
    s_add_u32 s59, s43, 2560
    buffer_load_dwordx4 v[140:143], v14, s[36:39], s59 offen sc1
    buffer_load_dwordx4 v[144:147], v14, s[36:39], s59 offen offset:1024 sc1
    buffer_load_dwordx2 v[150:151], v17, s[36:39], s59 offen offset:2048 sc1
    s_mov_b32 s63, 0
GB_WD:
    v_max_u32 v2, v72, v73
    v_max3_u32 v2, v2, v74, v75
    v_max3_u32 v2, v2, v76, v77
    v_max3_u32 v2, v2, v78, v79
    v_max3_u32 v2, v2, v80, v81
    v_max3_u32 v2, v2, v82, v83
    v_max3_u32 v2, v2, v84, v85
    v_max3_u32 v2, v2, v86, v87
    v_max3_u32 v2, v2, v88, v89
    v_max3_u32 v2, v2, v90, v91
    v_cmp_eq_u32 vcc, -1, v2
    s_cmp_gt_u32 s86, 200000
    s_waitcnt lgkmcnt(0)
    s_cbranch_scc1 GB_GO0
    s_nop 1
    s_cbranch_vccnz GB_NP0
GB_GO0:
    ds_read_b64_tr_b16 v[176:177], v4 offset:6400
    ds_read_b64_tr_b16 v[178:179], v4 offset:7680
    ds_read_b64_tr_b16 v[180:181], v4 offset:6464
    ds_read_b64_tr_b16 v[182:183], v4 offset:7744
    ds_read_b64_tr_b16 v[184:185], v5 offset:6400
    ds_read_b64_tr_b16 v[186:187], v5 offset:7680
    ds_read_b64_tr_b16 v[188:189], v4 offset:9600
    ds_read_b64_tr_b16 v[190:191], v4 offset:10880
    ds_read_b64_tr_b16 v[192:193], v4 offset:9664
    ds_read_b64_tr_b16 v[194:195], v4 offset:10944
    ds_read_b64_tr_b16 v[196:197], v5 offset:9600
    ds_read_b64_tr_b16 v[198:199], v5 offset:10880
    ds_read_b64_tr_b16 v[202:203], v6 offset:6400
    ds_read_b64_tr_b16 v[206:207], v6 offset:6464
    ds_read_b64_tr_b16 v[210:211], v7 offset:6400
    v_mfma_f32_32x32x16_bf16 v[24:39], v[152:155], v[72:75], v[24:39]
    v_mfma_f32_32x32x16_bf16 v[40:55], v[156:159], v[72:75], v[40:55]
    v_mfma_f32_32x32x16_bf16 v[56:71], v[160:163], v[72:75], v[56:71]
    v_mfma_f32_32x32x16_bf16 v[24:39], v[164:167], v[76:79], v[24:39]
    v_mfma_f32_32x32x16_bf16 v[40:55], v[168:171], v[76:79], v[40:55]
    v_mfma_f32_32x32x16_bf16 v[56:71], v[172:175], v[76:79], v[56:71]
    s_waitcnt lgkmcnt(0)
    v_mfma_f32_32x32x16_bf16 v[24:39], v[176:179], v[80:83], v[24:39]
    v_mfma_f32_32x32x16_bf16 v[40:55], v[180:183], v[80:83], v[40:55]
    v_mfma_f32_32x32x16_bf16 v[56:71], v[184:187], v[80:83], v[56:71]
    v_mfma_f32_32x32x16_bf16 v[24:39], v[188:191], v[84:87], v[24:39]
    v_mfma_f32_32x32x16_bf16 v[40:55], v[192:195], v[84:87], v[40:55]
    v_mfma_f32_32x32x16_bf16 v[56:71], v[196:199], v[84:87], v[56:71]
    v_mfma_f32_32x32x16_bf16 v[24:39], v[200:203], v[88:91], v[24:39]
    v_mfma_f32_32x32x16_bf16 v[40:55], v[204:207], v[88:91], v[40:55]
    v_mfma_f32_32x32x16_bf16 v[56:71], v[208:211], v[88:91], v[56:71]
    s_bitset1_b32 s63, 0
GB_NP0:
    s_bitcmp1_b32 s63, 1
    s_cbranch_scc1 GB_NP1
    v_add_u32 v4, s45, v224
    v_add_u32 v5, s45, v225
    v_add_u32 v6, s45, v226
    v_add_u32 v7, s45, v227
    ds_read_b64_tr_b16 v[152:153], v4 offset:0
    ds_read_b64_tr_b16 v[154:155], v4 offset:1280
    ds_read_b64_tr_b16 v[156:157], v4 offset:64
    ds_read_b64_tr_b16 v[158:159], v4 offset:1344
    ds_read_b64_tr_b16 v[160:161], v5 offset:0
    ds_read_b64_tr_b16 v[162:163], v5 offset:1280
    ds_read_b64_tr_b16 v[164:165], v4 offset:3200
    ds_read_b64_tr_b16 v[166:167], v4 offset:4480
    ds_read_b64_tr_b16 v[168:169], v4 offset:3264
    ds_read_b64_tr_b16 v[170:171], v4 offset:4544
    ds_read_b64_tr_b16 v[172:173], v5 offset:3200
    ds_read_b64_tr_b16 v[174:175], v5 offset:4480
    ds_read_b64_tr_b16 v[212:213], v6 offset:0
    ds_read_b64_tr_b16 v[216:217], v6 offset:64
    ds_read_b64_tr_b16 v[220:221], v7 offset:0
    s_cmp_eq_u32 s86, 1
    s_cbranch_scc1 GB_W1
    s_waitcnt vmcnt(0)
GB_W1:
    s_waitcnt vmcnt(12)
    v_max_u32 v2, v92, v93
    v_max3_u32 v2, v2, v94, v95
    v_max3_u32 v2, v2, v96, v97
    v_max3_u32 v2, v2, v98, v99
    v_max3_u32 v2, v2, v100, v101
    v_max3_u32 v2, v2, v102, v103
    v_max3_u32 v2, v2, v104, v105
    v_max3_u32 v2, v2, v106, v107
    v_max3_u32 v2, v2, v108, v109
    v_max3_u32 v2, v2, v110, v111
    v_cmp_eq_u32 vcc, -1, v2
    s_cmp_gt_u32 s86, 200000
    s_waitcnt lgkmcnt(0)
    s_cbranch_scc1 GB_GO1
    s_nop 1
    s_cbranch_vccnz GB_NP1
GB_GO1:
    ds_read_b64_tr_b16 v[176:177], v4 offset:6400
    ds_read_b64_tr_b16 v[178:179], v4 offset:7680
    ds_read_b64_tr_b16 v[180:181], v4 offset:6464
    ds_read_b64_tr_b16 v[182:183], v4 offset:7744
    ds_read_b64_tr_b16 v[184:185], v5 offset:6400
    ds_read_b64_tr_b16 v[186:187], v5 offset:7680
    ds_read_b64_tr_b16 v[188:189], v4 offset:9600
    ds_read_b64_tr_b16 v[190:191], v4 offset:10880
    ds_read_b64_tr_b16 v[192:193], v4 offset:9664
    ds_read_b64_tr_b16 v[194:195], v4 offset:10944
    ds_read_b64_tr_b16 v[196:197], v5 offset:9600
    ds_read_b64_tr_b16 v[198:199], v5 offset:10880
    ds_read_b64_tr_b16 v[214:215], v6 offset:6400
    ds_read_b64_tr_b16 v[218:219], v6 offset:6464
    ds_read_b64_tr_b16 v[222:223], v7 offset:6400
    v_mfma_f32_32x32x16_bf16 v[24:39], v[152:155], v[92:95], v[24:39]
    v_mfma_f32_32x32x16_bf16 v[40:55], v[156:159], v[92:95], v[40:55]
    v_mfma_f32_32x32x16_bf16 v[56:71], v[160:163], v[92:95], v[56:71]
    v_mfma_f32_32x32x16_bf16 v[24:39], v[164:167], v[96:99], v[24:39]
    v_mfma_f32_32x32x16_bf16 v[40:55], v[168:171], v[96:99], v[40:55]
    v_mfma_f32_32x32x16_bf16 v[56:71], v[172:175], v[96:99], v[56:71]
    s_waitcnt lgkmcnt(0)
    v_mfma_f32_32x32x16_bf16 v[24:39], v[176:179], v[100:103], v[24:39]
    v_mfma_f32_32x32x16_bf16 v[40:55], v[180:183], v[100:103], v[40:55]
    v_mfma_f32_32x32x16_bf16 v[56:71], v[184:187], v[100:103], v[56:71]
    v_mfma_f32_32x32x16_bf16 v[24:39], v[188:191], v[104:107], v[24:39]
    v_mfma_f32_32x32x16_bf16 v[40:55], v[192:195], v[104:107], v[40:55]
    v_mfma_f32_32x32x16_bf16 v[56:71], v[196:199], v[104:107], v[56:71]
    v_mfma_f32_32x32x16_bf16 v[24:39], v[212:215], v[108:111], v[24:39]
    v_mfma_f32_32x32x16_bf16 v[40:55], v[216:219], v[108:111], v[40:55]
    v_mfma_f32_32x32x16_bf16 v[56:71], v[220:223], v[108:111], v[56:71]
    s_bitset1_b32 s63, 1
GB_NP1:
    s_bitcmp1_b32 s63, 2
    s_cbranch_scc1 GB_NP2
    v_add_u32 v4, s46, v224
    v_add_u32 v5, s46, v225
    v_add_u32 v6, s46, v226
    v_add_u32 v7, s46, v227
    ds_read_b64_tr_b16 v[152:153], v4 offset:0
    ds_read_b64_tr_b16 v[154:155], v4 offset:1280
    ds_read_b64_tr_b16 v[156:157], v4 offset:64
    ds_read_b64_tr_b16 v[158:159], v4 offset:1344
    ds_read_b64_tr_b16 v[160:161], v5 offset:0
    ds_read_b64_tr_b16 v[162:163], v5 offset:1280
    ds_read_b64_tr_b16 v[164:165], v4 offset:3200
    ds_read_b64_tr_b16 v[166:167], v4 offset:4480
    ds_read_b64_tr_b16 v[168:169], v4 offset:3264
    ds_read_b64_tr_b16 v[170:171], v4 offset:4544
    ds_read_b64_tr_b16 v[172:173], v5 offset:3200
    ds_read_b64_tr_b16 v[174:175], v5 offset:4480
    ds_read_b64_tr_b16 v[200:201], v6 offset:0
    ds_read_b64_tr_b16 v[204:205], v6 offset:64
    ds_read_b64_tr_b16 v[208:209], v7 offset:0
    s_cmp_eq_u32 s86, 1
    s_cbranch_scc1 GB_W2
    s_waitcnt vmcnt(0)
GB_W2:
    s_waitcnt vmcnt(6)
    v_max_u32 v2, v112, v113
    v_max3_u32 v2, v2, v114, v115
    v_max3_u32 v2, v2, v116, v117
    v_max3_u32 v2, v2, v118, v119
    v_max3_u32 v2, v2, v120, v121
    v_max3_u32 v2, v2, v122, v123
    v_max3_u32 v2, v2, v124, v125
    v_max3_u32 v2, v2, v126, v127
    v_max3_u32 v2, v2, v128, v129
    v_max3_u32 v2, v2, v130, v131
    v_cmp_eq_u32 vcc, -1, v2
    s_cmp_gt_u32 s86, 200000
    s_waitcnt lgkmcnt(0)
    s_cbranch_scc1 GB_GO2
    s_nop 1
    s_cbranch_vccnz GB_NP2
GB_GO2:
    ds_read_b64_tr_b16 v[176:177], v4 offset:6400
    ds_read_b64_tr_b16 v[178:179], v4 offset:7680
    ds_read_b64_tr_b16 v[180:181], v4 offset:6464
    ds_read_b64_tr_b16 v[182:183], v4 offset:7744
    ds_read_b64_tr_b16 v[184:185], v5 offset:6400
    ds_read_b64_tr_b16 v[186:187], v5 offset:7680
    ds_read_b64_tr_b16 v[188:189], v4 offset:9600
    ds_read_b64_tr_b16 v[190:191], v4 offset:10880
    ds_read_b64_tr_b16 v[192:193], v4 offset:9664
    ds_read_b64_tr_b16 v[194:195], v4 offset:10944
    ds_read_b64_tr_b16 v[196:197], v5 offset:9600
    ds_read_b64_tr_b16 v[198:199], v5 offset:10880
    ds_read_b64_tr_b16 v[202:203], v6 offset:6400
    ds_read_b64_tr_b16 v[206:207], v6 offset:6464
    ds_read_b64_tr_b16 v[210:211], v7 offset:6400
    v_mfma_f32_32x32x16_bf16 v[24:39], v[152:155], v[112:115], v[24:39]
    v_mfma_f32_32x32x16_bf16 v[40:55], v[156:159], v[112:115], v[40:55]
    v_mfma_f32_32x32x16_bf16 v[56:71], v[160:163], v[112:115], v[56:71]
    v_mfma_f32_32x32x16_bf16 v[24:39], v[164:167], v[116:119], v[24:39]
    v_mfma_f32_32x32x16_bf16 v[40:55], v[168:171], v[116:119], v[40:55]
    v_mfma_f32_32x32x16_bf16 v[56:71], v[172:175], v[116:119], v[56:71]
    s_waitcnt lgkmcnt(0)
    v_mfma_f32_32x32x16_bf16 v[24:39], v[176:179], v[120:123], v[24:39]
    v_mfma_f32_32x32x16_bf16 v[40:55], v[180:183], v[120:123], v[40:55]
    v_mfma_f32_32x32x16_bf16 v[56:71], v[184:187], v[120:123], v[56:71]
    v_mfma_f32_32x32x16_bf16 v[24:39], v[188:191], v[124:127], v[24:39]
    v_mfma_f32_32x32x16_bf16 v[40:55], v[192:195], v[124:127], v[40:55]
    v_mfma_f32_32x32x16_bf16 v[56:71], v[196:199], v[124:127], v[56:71]
    v_mfma_f32_32x32x16_bf16 v[24:39], v[200:203], v[128:131], v[24:39]
    v_mfma_f32_32x32x16_bf16 v[40:55], v[204:207], v[128:131], v[40:55]
    v_mfma_f32_32x32x16_bf16 v[56:71], v[208:211], v[128:131], v[56:71]
    s_bitset1_b32 s63, 2
GB_NP2:
    s_bitcmp1_b32 s63, 3
    s_cbranch_scc1 GB_NP3
    v_add_u32 v4, s47, v224
    v_add_u32 v5, s47, v225
    v_add_u32 v6, s47, v226
    v_add_u32 v7, s47, v227
    ds_read_b64_tr_b16 v[152:153], v4 offset:0
    ds_read_b64_tr_b16 v[154:155], v4 offset:1280
    ds_read_b64_tr_b16 v[156:157], v4 offset:64
    ds_read_b64_tr_b16 v[158:159], v4 offset:1344
    ds_read_b64_tr_b16 v[160:161], v5 offset:0
    ds_read_b64_tr_b16 v[162:163], v5 offset:1280
    ds_read_b64_tr_b16 v[164:165], v4 offset:3200
    ds_read_b64_tr_b16 v[166:167], v4 offset:4480
    ds_read_b64_tr_b16 v[168:169], v4 offset:3264
    ds_read_b64_tr_b16 v[170:171], v4 offset:4544
    ds_read_b64_tr_b16 v[172:173], v5 offset:3200
    ds_read_b64_tr_b16 v[174:175], v5 offset:4480
    ds_read_b64_tr_b16 v[212:213], v6 offset:0
    ds_read_b64_tr_b16 v[216:217], v6 offset:64
    ds_read_b64_tr_b16 v[220:221], v7 offset:0
    s_cmp_eq_u32 s86, 1
    s_cbranch_scc1 GB_W3
    s_waitcnt vmcnt(0)
GB_W3:
    s_waitcnt vmcnt(0)
    v_max_u32 v2, v132, v133
    v_max3_u32 v2, v2, v134, v135
    v_max3_u32 v2, v2, v136, v137
    v_max3_u32 v2, v2, v138, v139
    v_max3_u32 v2, v2, v140, v141
    v_max3_u32 v2, v2, v142, v143
    v_max3_u32 v2, v2, v144, v145
    v_max3_u32 v2, v2, v146, v147
    v_max3_u32 v2, v2, v148, v149
    v_max3_u32 v2, v2, v150, v151
    v_cmp_eq_u32 vcc, -1, v2
    s_cmp_gt_u32 s86, 200000
    s_waitcnt lgkmcnt(0)
    s_cbranch_scc1 GB_GO3
    s_nop 1
    s_cbranch_vccnz GB_NP3
GB_GO3:
    ds_read_b64_tr_b16 v[176:177], v4 offset:6400
    ds_read_b64_tr_b16 v[178:179], v4 offset:7680
    ds_read_b64_tr_b16 v[180:181], v4 offset:6464
    ds_read_b64_tr_b16 v[182:183], v4 offset:7744
    ds_read_b64_tr_b16 v[184:185], v5 offset:6400
    ds_read_b64_tr_b16 v[186:187], v5 offset:7680
    ds_read_b64_tr_b16 v[188:189], v4 offset:9600
    ds_read_b64_tr_b16 v[190:191], v4 offset:10880
    ds_read_b64_tr_b16 v[192:193], v4 offset:9664
    ds_read_b64_tr_b16 v[194:195], v4 offset:10944
    ds_read_b64_tr_b16 v[196:197], v5 offset:9600
    ds_read_b64_tr_b16 v[198:199], v5 offset:10880
    ds_read_b64_tr_b16 v[214:215], v6 offset:6400
    ds_read_b64_tr_b16 v[218:219], v6 offset:6464
    ds_read_b64_tr_b16 v[222:223], v7 offset:6400
    v_mfma_f32_32x32x16_bf16 v[24:39], v[152:155], v[132:135], v[24:39]
    v_mfma_f32_32x32x16_bf16 v[40:55], v[156:159], v[132:135], v[40:55]
    v_mfma_f32_32x32x16_bf16 v[56:71], v[160:163], v[132:135], v[56:71]
    v_mfma_f32_32x32x16_bf16 v[24:39], v[164:167], v[136:139], v[24:39]
    v_mfma_f32_32x32x16_bf16 v[40:55], v[168:171], v[136:139], v[40:55]
    v_mfma_f32_32x32x16_bf16 v[56:71], v[172:175], v[136:139], v[56:71]
    s_waitcnt lgkmcnt(0)
    v_mfma_f32_32x32x16_bf16 v[24:39], v[176:179], v[140:143], v[24:39]
    v_mfma_f32_32x32x16_bf16 v[40:55], v[180:183], v[140:143], v[40:55]
    v_mfma_f32_32x32x16_bf16 v[56:71], v[184:187], v[140:143], v[56:71]
    v_mfma_f32_32x32x16_bf16 v[24:39], v[188:191], v[144:147], v[24:39]
    v_mfma_f32_32x32x16_bf16 v[40:55], v[192:195], v[144:147], v[40:55]
    v_mfma_f32_32x32x16_bf16 v[56:71], v[196:199], v[144:147], v[56:71]
    v_mfma_f32_32x32x16_bf16 v[24:39], v[212:215], v[148:151], v[24:39]
    v_mfma_f32_32x32x16_bf16 v[40:55], v[216:219], v[148:151], v[40:55]
    v_mfma_f32_32x32x16_bf16 v[56:71], v[220:223], v[148:151], v[56:71]
    s_bitset1_b32 s63, 3
GB_NP3:
    s_cmp_eq_u32 s63, 15
    s_cbranch_scc1 GB_TD
    s_sleep 4
    s_branch GB_PASS
GB_TD:
    s_nop 9
    ds_write_b128 v239, v[24:27] offset:0
    ds_write_b128 v239, v[28:31] offset:32
    ds_write_b128 v239, v[32:35] offset:64
    ds_write_b128 v239, v[36:39] offset:96
    ds_write_b128 v239, v[40:43] offset:128
    ds_write_b128 v239, v[44:47] offset:160
    ds_write_b128 v239, v[48:51] offset:192
    ds_write_b128 v239, v[52:55] offset:224
    ds_write_b128 v239, v[56:59] offset:256
    ds_write_b128 v239, v[60:63] offset:288
FINAL_SUM:
    s_waitcnt lgkmcnt(0)
    s_barrier
    ds_read_b128 v[72:75], v244 offset:0
    ds_read_b128 v[76:79], v244 offset:16
    ds_read_b128 v[80:83], v244 offset:21504
    ds_read_b128 v[84:87], v244 offset:21520
    s_waitcnt lgkmcnt(0)
    v_pk_add_f32 v[72:73], v[72:73], v[80:81]
    v_pk_add_f32 v[74:75], v[74:75], v[82:83]
    v_pk_add_f32 v[76:77], v[76:77], v[84:85]
    v_pk_add_f32 v[78:79], v[78:79], v[86:87]
    v_cvt_pk_bf16_f32 v80, v72, v73
    v_cvt_pk_bf16_f32 v81, v74, v75
    v_cvt_pk_bf16_f32 v82, v76, v77
    v_cvt_pk_bf16_f32 v83, v78, v79
    buffer_store_dwordx4 v[80:83], v246, s[28:31], s78 offen
    s_cmp_ge_u32 s52, 2
    s_cbranch_scc1 P_FIN
    ds_read_b128 v[88:91], v245 offset:0
    ds_read_b128 v[92:95], v245 offset:16
    ds_read_b128 v[96:99], v245 offset:21504
    ds_read_b128 v[100:103], v245 offset:21520
    s_waitcnt lgkmcnt(0)
    v_pk_add_f32 v[88:89], v[88:89], v[96:97]
    v_pk_add_f32 v[90:91], v[90:91], v[98:99]
    v_pk_add_f32 v[92:93], v[92:93], v[100:101]
    v_pk_add_f32 v[94:95], v[94:95], v[102:103]
    v_cvt_pk_bf16_f32 v96, v88, v89
    v_cvt_pk_bf16_f32 v97, v90, v91
    v_cvt_pk_bf16_f32 v98, v92, v93
    v_cvt_pk_bf16_f32 v99, v94, v95
    buffer_store_dwordx4 v[96:99], v247, s[28:31], s78 offen
P_FIN:
P_END:
    s_endpgm
FINAL_REDUCE:
    s_mov_b32 s28, s22
    s_and_b32 s29, s23, 0xffff
    s_mov_b32 s30, 2621440
    s_mov_b32 s31, 0x00020000
    s_lshr_b32 s59, s55, 3
    s_lshl1_add_u32 s59, s54, s59
    s_mul_i32 s59, s59, 81920
    s_and_b32 s60, s55, 7
    s_mul_i32 s60, s60, 160
    s_add_u32 s78, s59, s60
    s_branch FINAL_SUM
GA:
    s_waitcnt lgkmcnt(0)
    s_mov_b32 s36, s26
    s_and_b32 s37, s27, 0xffff
    s_mov_b32 s38, 20971520
    s_mov_b32 s39, 0x00020000
    s_or_b32 s59, s2, s53
    s_cmp_lg_u32 s59, 0
    s_cbranch_scc1 GA_NON
    s_memrealtime s[72:73]
    s_mov_b32 s48, s24
    s_and_b32 s49, s25, 0xffff
    s_mov_b32 s50, 256
    s_mov_b32 s51, 0x00020000
    s_waitcnt lgkmcnt(0)
    s_or_b32 s59, s72, 1
    v_mov_b32 v28, s59
    v_mov_b32 v29, 0
    s_mov_b64 exec, 1
    buffer_store_dword v28, v29, s[48:51], 0 offen sc1
    s_mov_b64 exec, -1
GA_NON:
    s_and_b32 s59, s53, 2
    s_mul_i32 s59, s59, 10240
    s_add_u32 s59, s59, 36864
    v_mov_b32 v32, 0
    v_mov_b32 v33, 0
    v_mov_b32 v34, 0
    v_mov_b32 v35, 0
    v_and_b32 v28, 7, v1
    v_lshlrev_b32 v28, 4, v28
    v_add_u32 v28, 162304, v28
    ds_write_b128 v28, v[32:35]
    v_and_b32 v2, 31, v1
    v_lshrrev_b32 v3, 5, v1
    v_bfe_u32 v28, v2, 1, 3
    v_xor_b32 v3, v3, v28
    v_lshlrev_b32 v3, 4, v3
    v_lshl_add_u32 v3, v2, 7, v3
    v_xor_b32 v28, 0, v3
    v_add_u32 v4, s59, v28
    v_xor_b32 v28, 32, v3
    v_add_u32 v5, s59, v28
    v_xor_b32 v28, 64, v3
    v_add_u32 v6, s59, v28
    v_xor_b32 v28, 96, v3
    v_add_u32 v7, s59, v28
    v_lshrrev_b32 v2, 5, v1
    v_bfe_u32 v28, v1, 2, 2
    v_lshl_add_u32 v2, v2, 3, v28
    v_bfe_u32 v3, v1, 4, 1
    v_and_b32 v28, 3, v1
    v_lshl_add_u32 v3, v3, 2, v28
    v_and_b32 v27, 3, v2
    v_lshlrev_b32 v27, 6, v27
    v_lshl_add_u32 v27, v2, 8, v27
    v_lshl_add_u32 v27, v3, 3, v27
    v_and_b32 v28, 31, v1
    v_lshrrev_b32 v29, 5, v1
    v_lshlrev_b32 v224, 4, v1
    v_lshlrev_b32 v225, 3, v28
    v_and_b32 v30, 27, v28
    v_cmp_eq_u32 vcc, 24, v30
    v_mov_b32 v30, 21
    v_cmp_gt_u32 s[72:73], 20, v28
    v_cndmask_b32 v30, v30, 20, vcc
    v_mul_u32_u24 v31, 352, v29
    v_cndmask_b32 v30, v30, v28, s[72:73]
    v_lshl_add_u32 v226, v30, 4, v31
    v_mov_b32 v227, v224
    v_mov_b32 v228, v225
    v_mov_b32 v229, v226
    s_mov_b32 s69, 43008
    v_add_u32 v230, s69, v224
    v_add_u32 v231, s69, v225
    v_add_u32 v232, s69, v226
    v_mov_b32 v233, 0xdddd
    v_mov_b32 v235, 1
    v_mov_b32 v234, 162304
    v_lshlrev_b32 v30, 3, v1
    s_and_b32 s59, s53, 2
    s_lshl_b32 s60, s59, 13
    s_add_u32 s60, s60, 129024
    v_add_u32 v238, s60, v30
    s_mul_i32 s60, s59, 1280
    s_add_u32 s60, s60, 88064
    v_add_u32 v239, s60, v224
    v_lshlrev_b32 v30, 3, v1
    v_add_u32 v240, s60, v30
    s_lshl_b32 s60, s53, 7
    s_add_u32 s60, s60, 161792
    v_lshlrev_b32 v30, 2, v28
    v_add_u32 v241, s60, v30
    v_add_u32 v28, 0, v0
    v_mul_u32_u24 v29, 6554, v28
    v_lshrrev_b32 v29, 16, v29
    v_mul_u32_u24 v30, 10, v29
    v_sub_u32 v28, v28, v30
    v_mul_u32_u24 v30, 336, v29
    v_lshl_add_u32 v244, v28, 5, v30
    v_and_b32 v30, 31, v29
    v_lshrrev_b32 v29, 5, v29
    v_lshl_add_u32 v29, v30, 1, v29
    v_mul_u32_u24 v29, 1280, v29
    v_lshl_add_u32 v246, v28, 4, v29
    v_add_u32 v28, 512, v0
    v_mul_u32_u24 v29, 6554, v28
    v_lshrrev_b32 v29, 16, v29
    v_mul_u32_u24 v30, 10, v29
    v_sub_u32 v28, v28, v30
    v_mul_u32_u24 v30, 336, v29
    v_lshl_add_u32 v245, v28, 5, v30
    v_and_b32 v30, 31, v29
    v_lshrrev_b32 v29, 5, v29
    v_lshl_add_u32 v29, v30, 1, v29
    v_mul_u32_u24 v29, 1280, v29
    v_lshl_add_u32 v247, v28, 4, v29
    v_lshlrev_b32 v252, 4, v1
    s_mul_i32 s59, s53, 5120
    v_add_u32 v253, s59, v252
    s_cmp_ge_u32 s56, 2
    s_cselect_b32 s59, 8, 0
    v_and_b32 v248, 31, v1
    v_lshrrev_b32 v249, 5, v1
    v_lshlrev_b32 v249, 2, v249
    v_sub_u32 v248, v248, v249
    v_mov_b32 v249, 0xff800000
    v_subrev_u32 v250, 0, v248
    v_subrev_u32 v251, 1, v248
    v_cmp_gt_u32 vcc, 8, v250
    v_cmp_gt_u32 s[74:75], 8, v251
    s_nop 0
    v_cndmask_b32 v72, v249, 0, vcc
    v_cndmask_b32 v73, v249, 0, s[74:75]
    v_subrev_u32 v250, 2, v248
    v_subrev_u32 v251, 3, v248
    v_cmp_gt_u32 vcc, 8, v250
    v_cmp_gt_u32 s[74:75], 8, v251
    s_nop 0
    v_cndmask_b32 v74, v249, 0, vcc
    v_cndmask_b32 v75, v249, 0, s[74:75]
    v_subrev_u32 v250, 8, v248
    v_subrev_u32 v251, 9, v248
    v_cmp_gt_u32 vcc, 8, v250
    v_cmp_gt_u32 s[74:75], 8, v251
    s_nop 0
    v_cndmask_b32 v76, v249, 0, vcc
    v_cndmask_b32 v77, v249, 0, s[74:75]
    v_subrev_u32 v250, 10, v248
    v_subrev_u32 v251, 11, v248
    v_cmp_gt_u32 vcc, 8, v250
    v_cmp_gt_u32 s[74:75], 8, v251
    s_nop 0
    v_cndmask_b32 v78, v249, 0, vcc
    v_cndmask_b32 v79, v249, 0, s[74:75]
    v_subrev_u32 v250, 16, v248
    v_subrev_u32 v251, 17, v248
    v_cmp_gt_u32 vcc, 8, v250
    v_cmp_gt_u32 s[74:75], 8, v251
    s_nop 0
    v_cndmask_b32 v80, v249, 0, vcc
    v_cndmask_b32 v81, v249, 0, s[74:75]
    v_subrev_u32 v250, 18, v248
    v_subrev_u32 v251, 19, v248
    v_cmp_gt_u32 vcc, 8, v250
    v_cmp_gt_u32 s[74:75], 8, v251
    s_nop 0
    v_cndmask_b32 v82, v249, 0, vcc
    v_cndmask_b32 v83, v249, 0, s[74:75]
    v_subrev_u32 v250, 24, v248
    v_subrev_u32 v251, 25, v248
    v_cmp_gt_u32 vcc, 8, v250
    v_cmp_gt_u32 s[74:75], 8, v251
    s_nop 0
    v_cndmask_b32 v84, v249, 0, vcc
    v_cndmask_b32 v85, v249, 0, s[74:75]
    v_subrev_u32 v250, 26, v248
    v_subrev_u32 v251, 27, v248
    v_cmp_gt_u32 vcc, 8, v250
    v_cmp_gt_u32 s[74:75], 8, v251
    s_nop 0
    v_cndmask_b32 v86, v249, 0, vcc
    v_cndmask_b32 v87, v249, 0, s[74:75]
    v_add_u32 v250, 8, v248
    v_add_u32 v251, 7, v248
    v_cmp_gt_u32 vcc, s59, v250
    v_cmp_gt_u32 s[74:75], s59, v251
    s_nop 0
    v_cndmask_b32 v88, v249, 0, vcc
    v_cndmask_b32 v89, v249, 0, s[74:75]
    v_add_u32 v250, 6, v248
    v_add_u32 v251, 5, v248
    v_cmp_gt_u32 vcc, s59, v250
    v_cmp_gt_u32 s[74:75], s59, v251
    s_nop 0
    v_cndmask_b32 v90, v249, 0, vcc
    v_cndmask_b32 v91, v249, 0, s[74:75]
    ds_write_b128 v252, v[72:75] offset:0
    ds_write_b128 v252, v[76:79] offset:1024
    ds_write_b128 v252, v[80:83] offset:2048
    ds_write_b128 v252, v[84:87] offset:3072
    ds_write_b128 v253, v[88:91] offset:6144
    s_waitcnt lgkmcnt(0)
    s_cmp_ge_u32 s56, 2
    s_cselect_b32 s63, 2, 0
    v_lshrrev_b32 v2, 1, v1
    v_min_u32 v2, 4, v2
    v_cmp_lt_u32 vcc, 2, v2
    v_subrev_u32 v3, 2, v2
    s_mul_i32 s59, s55, 5
    v_cndmask_b32 v2, v2, v3, vcc
    v_mul_u32_u24 v2, 80, v2
    v_and_b32 v3, 1, v1
    v_lshl_add_u32 v2, v3, 2, v2
    v_add_u32 v2, s59, v2
    v_lshrrev_b32 v2, 4, v2
    s_lshl_b32 s59, s63, 4
    v_mov_b32 v3, s59
    v_cndmask_b32 v3, v3, 0, vcc
    v_add_lshl_u32 v86, v2, v3, 2
    v_and_b32 v248, 31, v1
    v_lshrrev_b32 v249, 5, v1
    v_lshlrev_b32 v2, 3, v249
    v_lshl_add_u32 v83, v248, 4, v2
    s_lshl_b32 s59, s53, 7
    s_add_u32 s59, s59, 161792
    v_lshlrev_b32 v2, 2, v248
    v_add_u32 v90, s59, v2
    v_mul_u32_u24 v2, 336, v248
    v_lshl_add_u32 v2, v249, 4, v2
    s_mul_i32 s59, s53, 10752
    v_add_u32 v87, s59, v2
    v_mov_b32 v89, 0xdddd
    v_mov_b32 v91, 0
    s_lshl_b32 s60, s53, 13
    s_add_u32 s60, s60, 129024
    v_lshrrev_b32 v2, 5, v1
    v_bfe_u32 v248, v1, 2, 2
    v_lshl_add_u32 v2, v2, 3, v248
    v_bfe_u32 v3, v1, 4, 1
    v_and_b32 v248, 3, v1
    v_lshl_add_u32 v3, v3, 2, v248
    v_min_u32 v250, 4, v3
    v_lshlrev_b32 v251, 4, v2
    v_add_u32 v251, s60, v251
    v_add_u32 v248, 0, v250
    v_lshrrev_b32 v249, 1, v248
    v_and_b32 v248, 1, v248
    v_lshl_add_u32 v249, v249, 9, v251
    v_lshl_add_u32 v84, v248, 3, v249
    v_add_u32 v248, 5, v250
    v_lshrrev_b32 v249, 1, v248
    v_and_b32 v248, 1, v248
    v_lshl_add_u32 v249, v249, 9, v251
    v_lshl_add_u32 v85, v248, 3, v249
    v_lshrrev_b32 v248, 5, v1
    v_lshlrev_b32 v249, 2, v248
    v_sub_u32 v2, v2, v249
    v_mul_u32_u24 v249, 160, v2
    v_lshl_add_u32 v2, v248, 4, v2
    v_add_u32 v2, 16, v2
    v_mul_u32_u24 v250, 160, v2
    v_lshlrev_b32 v2, 3, v3
    v_and_b32 v3, 3, v3
    v_lshlrev_b32 v3, 3, v3
    v_add_u32 v3, 128, v3
    v_add3_u32 v72, v249, v2, s60
    v_add3_u32 v73, v249, v3, s60
    v_add3_u32 v74, v250, v2, s60
    v_add3_u32 v75, v250, v3, s60
    v_add_u32 v2, 0, v1
    v_mul_u32_u24 v3, 6554, v2
    v_lshrrev_b32 v3, 16, v3
    v_mul_u32_u24 v3, 1120, v3
    v_lshl_add_u32 v3, v2, 4, v3
    v_subrev_u32 v76, 0, v3
    v_add_u32 v2, 64, v1
    v_mul_u32_u24 v3, 6554, v2
    v_lshrrev_b32 v3, 16, v3
    v_mul_u32_u24 v3, 1120, v3
    v_lshl_add_u32 v3, v2, 4, v3
    v_subrev_u32 v77, 1024, v3
    v_add_u32 v2, 128, v1
    v_mul_u32_u24 v3, 6554, v2
    v_lshrrev_b32 v3, 16, v3
    v_mul_u32_u24 v3, 1120, v3
    v_lshl_add_u32 v3, v2, 4, v3
    v_subrev_u32 v78, 2048, v3
    v_add_u32 v2, 192, v1
    v_mul_u32_u24 v3, 6554, v2
    v_lshrrev_b32 v3, 16, v3
    v_mul_u32_u24 v3, 1120, v3
    v_lshl_add_u32 v3, v2, 4, v3
    v_subrev_u32 v79, 3072, v3
    v_add_u32 v2, 256, v1
    v_mul_u32_u24 v3, 6554, v2
    v_lshrrev_b32 v3, 16, v3
    v_mul_u32_u24 v3, 1120, v3
    v_lshl_add_u32 v3, v2, 4, v3
    v_subrev_u32 v80, 0, v3
    v_add_u32 v2, 320, v1
    v_mul_u32_u24 v3, 6554, v2
    v_lshrrev_b32 v3, 16, v3
    v_mul_u32_u24 v3, 1120, v3
    v_lshl_add_u32 v3, v2, 4, v3
    v_subrev_u32 v81, 1024, v3
    v_add_u32 v2, 384, v1
    v_mul_u32_u24 v3, 6554, v2
    v_lshrrev_b32 v3, 16, v3
    v_mul_u32_u24 v3, 1120, v3
    v_lshl_add_u32 v3, v2, 4, v3
    v_subrev_u32 v82, 2048, v3
    v_mul_u32_u24 v2, 10923, v1
    v_lshrrev_b32 v2, 16, v2
    v_mul_u32_u24 v3, 6, v2
    v_sub_u32 v3, v1, v3
    v_min_u32 v2, 9, v2
    v_mul_u32_u24 v2, 1280, v2
    v_lshlrev_b32 v3, 7, v3
    v_min_u32 v3, 636, v3
    v_add_u32 v88, v2, v3
    v_add_u32 v248, 256, v0
    v_mul_u32_u24 v249, 6554, v248
    v_lshrrev_b32 v249, 16, v249
    v_mul_u32_u24 v250, 10, v249
    v_sub_u32 v248, v248, v250
    v_mul_u32_u24 v250, 336, v249
    v_lshl_add_u32 v92, v248, 5, v250
    v_and_b32 v250, 31, v249
    v_lshrrev_b32 v249, 5, v249
    v_lshl_add_u32 v249, v250, 1, v249
    v_mul_u32_u24 v249, 1280, v249
    v_lshl_add_u32 v94, v248, 4, v249
    ds_write_b128 v253, v[72:75] offset:7168
    ds_write_b128 v252, v[76:79] offset:4096
    ds_write_b128 v252, v[80:83] offset:5120
    ds_write_b128 v253, v[84:87] offset:8192
    ds_write_b128 v253, v[88:91] offset:9216
    ds_write_b128 v253, v[92:95] offset:10240
    v_lshrrev_b32 v2, 5, v1
    v_bfe_u32 v28, v1, 2, 2
    v_lshl_add_u32 v2, v2, 3, v28
    v_bfe_u32 v3, v1, 4, 1
    v_and_b32 v28, 3, v1
    v_lshl_add_u32 v3, v3, 2, v28
    v_mov_b64 v[96:97], 0
    v_mov_b64 v[98:99], 0
    v_mov_b64 v[100:101], 0
    v_mov_b64 v[102:103], 0
    v_mov_b64 v[104:105], 0
    v_mov_b64 v[106:107], 0
    v_mov_b64 v[108:109], 0
    v_mov_b64 v[110:111], 0
    v_mov_b64 v[112:113], 0
    v_mov_b64 v[114:115], 0
    v_mov_b64 v[116:117], 0
    v_mov_b64 v[118:119], 0
    v_mov_b64 v[120:121], 0
    v_mov_b64 v[122:123], 0
    v_mov_b64 v[124:125], 0
    v_mov_b64 v[126:127], 0
    v_mov_b64 v[128:129], 0
    v_mov_b64 v[130:131], 0
    v_mov_b64 v[132:133], 0
    v_mov_b64 v[134:135], 0
    v_mov_b64 v[136:137], 0
    v_mov_b64 v[138:139], 0
    v_mov_b64 v[140:141], 0
    v_mov_b64 v[142:143], 0
    v_mov_b64 v[144:145], 0
    v_mov_b64 v[146:147], 0
    v_mov_b64 v[148:149], 0
    v_mov_b64 v[150:151], 0
    v_mov_b64 v[152:153], 0
    v_mov_b64 v[154:155], 0
    v_mov_b64 v[156:157], 0
    v_mov_b64 v[158:159], 0
    v_mov_b64 v[160:161], 0
    v_mov_b64 v[162:163], 0
    v_mov_b64 v[164:165], 0
    v_mov_b64 v[166:167], 0
    v_mov_b64 v[168:169], 0
    v_mov_b64 v[170:171], 0
    v_mov_b64 v[172:173], 0
    v_mov_b64 v[174:175], 0
    v_mov_b64 v[176:177], 0
    v_mov_b64 v[178:179], 0
    v_mov_b64 v[180:181], 0
    v_mov_b64 v[182:183], 0
    v_mov_b64 v[184:185], 0
    v_mov_b64 v[186:187], 0
    v_mov_b64 v[188:189], 0
    v_mov_b64 v[190:191], 0
    v_mov_b64 v[192:193], 0
    v_mov_b64 v[194:195], 0
    v_mov_b64 v[196:197], 0
    v_mov_b64 v[198:199], 0
    v_mov_b64 v[200:201], 0
    v_mov_b64 v[202:203], 0
    v_mov_b64 v[204:205], 0
    v_mov_b64 v[206:207], 0
    v_mov_b64 v[208:209], 0
    v_mov_b64 v[210:211], 0
    v_mov_b64 v[212:213], 0
    v_mov_b64 v[214:215], 0
    v_mov_b64 v[216:217], 0
    v_mov_b64 v[218:219], 0
    v_mov_b64 v[220:221], 0
    v_mov_b64 v[222:223], 0
    s_waitcnt lgkmcnt(0)
    s_bitcmp1_b32 s53, 0
    s_cbranch_scc1 GA_SET1
    v_lshlrev_b32 v28, 6, v2
    v_lshl_add_u32 v28, v3, 3, v28
    v_add_u32 v8, 45056, v28
    v_add_u32 v9, 45312, v28
    v_mul_u32_u24 v28, 24, v3
    v_cmp_gt_u32 vcc, 2, v3
    v_cmp_gt_u32 s[72:73], 4, v3
    v_lshl_add_u32 v28, v2, 5, v28
    v_add_u32 v28, 46080, v28
    v_lshlrev_b32 v29, 3, v2
    v_add_u32 v29, 46720, v29
    v_mov_b32 v30, 46912
    v_cndmask_b32 v29, v30, v29, s[72:73]
    v_cndmask_b32 v10, v29, v28, vcc
    v_add_u32 v28, 128, v28
    v_add_u32 v29, 32, v29
    v_cndmask_b32 v11, v29, v28, vcc
    v_add_u32 v12, 40960, v27
    v_add_u32 v13, 41984, v27
    s_cmp_eq_u32 s55, 15
    s_cbranch_scc1 GA_SPEC0
    s_branch GA_NORM
GA_SET1:
    s_cmp_eq_u32 s55, 15
    s_cbranch_scc1 GA_SPEC1
    v_xor_b32 v28, 64, v27
    v_add_u32 v8, 40960, v28
    v_add_u32 v9, 41984, v28
    v_xor_b32 v28, 128, v27
    v_add_u32 v10, 40960, v28
    v_add_u32 v11, 41984, v28
    v_xor_b32 v28, 192, v27
    v_add_u32 v12, 40960, v28
    v_add_u32 v13, 41984, v28
GA_NORM:
    s_mov_b32 s68, 0
    v_add_u32 v14, s68, v4
    v_add_u32 v15, s68, v5
    v_add_u32 v16, s68, v6
    v_add_u32 v17, s68, v7
    v_add_u32 v18, s68, v8
    v_add_u32 v19, s68, v9
    v_add_u32 v20, s68, v10
    v_add_u32 v21, s68, v11
    v_add_u32 v22, s68, v12
    v_add_u32 v23, s68, v13
    s_barrier
    ds_read_b128 v[32:35], v14
    ds_read_b64_tr_b16 v[40:41], v18 offset:0
    ds_read_b64_tr_b16 v[42:43], v19 offset:0
    ds_read_b128 v[36:39], v14 offset:10240
    ds_read_b64_tr_b16 v[44:45], v20 offset:0
    ds_read_b64_tr_b16 v[46:47], v21 offset:0
    ds_read_b64_tr_b16 v[48:49], v22 offset:0
    ds_read_b64_tr_b16 v[50:51], v23 offset:0
    s_mov_b32 s65, 0
.p2align 3
P1_N:
    s_waitcnt lgkmcnt(5)
    v_mfma_f32_32x32x16_bf16 v[96:111], v[40:43], v[32:35], v[96:111]
    ds_read_b128 v[52:55], v15
    ds_read_b64_tr_b16 v[60:61], v18 offset:10240
    s_waitcnt lgkmcnt(6)
    v_mfma_f32_32x32x16_bf16 v[144:159], v[40:43], v[36:39], v[144:159]
    ds_read_b64_tr_b16 v[62:63], v19 offset:10240
    ds_read_b128 v[56:59], v15 offset:10240
    s_waitcnt lgkmcnt(6)
    v_mfma_f32_32x32x16_bf16 v[112:127], v[44:47], v[32:35], v[112:127]
    ds_read_b64_tr_b16 v[64:65], v20 offset:10240
    ds_read_b64_tr_b16 v[66:67], v21 offset:10240
    v_mfma_f32_32x32x16_bf16 v[160:175], v[44:47], v[36:39], v[160:175]
    ds_read_b64_tr_b16 v[68:69], v22 offset:10240
    ds_read_b64_tr_b16 v[70:71], v23 offset:10240
    s_waitcnt lgkmcnt(8)
    v_mfma_f32_32x32x16_bf16 v[128:143], v[48:51], v[32:35], v[128:143]
    v_mfma_f32_32x32x16_bf16 v[176:191], v[48:51], v[36:39], v[176:191]
    s_add_u32 s68, s68, 40960
    s_cmp_ge_u32 s68, 122880
    s_cselect_b32 s68, 0, s68
    s_waitcnt lgkmcnt(5)
    v_mfma_f32_32x32x16_bf16 v[96:111], v[60:63], v[52:55], v[96:111]
    ds_read_b128 v[32:35], v16
    ds_read_b64_tr_b16 v[40:41], v18 offset:20480
    s_waitcnt lgkmcnt(6)
    v_mfma_f32_32x32x16_bf16 v[144:159], v[60:63], v[56:59], v[144:159]
    ds_read_b64_tr_b16 v[42:43], v19 offset:20480
    ds_read_b128 v[36:39], v16 offset:10240
    s_waitcnt lgkmcnt(6)
    v_mfma_f32_32x32x16_bf16 v[112:127], v[64:67], v[52:55], v[112:127]
    ds_read_b64_tr_b16 v[44:45], v20 offset:20480
    ds_read_b64_tr_b16 v[46:47], v21 offset:20480
    v_mfma_f32_32x32x16_bf16 v[160:175], v[64:67], v[56:59], v[160:175]
    ds_read_b64_tr_b16 v[48:49], v22 offset:20480
    ds_read_b64_tr_b16 v[50:51], v23 offset:20480
    s_waitcnt lgkmcnt(8)
    v_mfma_f32_32x32x16_bf16 v[128:143], v[68:71], v[52:55], v[128:143]
    v_mfma_f32_32x32x16_bf16 v[176:191], v[68:71], v[56:59], v[176:191]
    v_add_u32 v14, s68, v4
    v_add_u32 v15, s68, v5
    v_add_u32 v16, s68, v6
    s_waitcnt lgkmcnt(5)
    v_mfma_f32_32x32x16_bf16 v[96:111], v[40:43], v[32:35], v[96:111]
    ds_read_b128 v[52:55], v17
    ds_read_b64_tr_b16 v[60:61], v18 offset:30720
    s_waitcnt lgkmcnt(6)
    v_mfma_f32_32x32x16_bf16 v[144:159], v[40:43], v[36:39], v[144:159]
    ds_read_b64_tr_b16 v[62:63], v19 offset:30720
    ds_read_b128 v[56:59], v17 offset:10240
    s_waitcnt lgkmcnt(6)
    v_mfma_f32_32x32x16_bf16 v[112:127], v[44:47], v[32:35], v[112:127]
    ds_read_b64_tr_b16 v[64:65], v20 offset:30720
    ds_read_b64_tr_b16 v[66:67], v21 offset:30720
    v_mfma_f32_32x32x16_bf16 v[160:175], v[44:47], v[36:39], v[160:175]
    ds_read_b64_tr_b16 v[68:69], v22 offset:30720
    ds_read_b64_tr_b16 v[70:71], v23 offset:30720
    s_waitcnt lgkmcnt(8)
    v_mfma_f32_32x32x16_bf16 v[128:143], v[48:51], v[32:35], v[128:143]
    v_add_u32 v18, s68, v8
    v_add_u32 v19, s68, v9
    v_add_u32 v20, s68, v10
    v_mfma_f32_32x32x16_bf16 v[176:191], v[48:51], v[36:39], v[176:191]
    v_add_u32 v21, s68, v11
    v_add_u32 v22, s68, v12
    v_add_u32 v23, s68, v13
    s_cmp_ge_u32 s65, 8
    s_waitcnt lgkmcnt(0)
    v_mfma_f32_32x32x16_bf16 v[96:111], v[60:63], v[52:55], v[96:111]
    s_cbranch_scc1 P1SB_N
    s_barrier
P1NB_N:
    ds_read_b128 v[32:35], v14
    ds_read_b64_tr_b16 v[40:41], v18 offset:0
    v_mfma_f32_32x32x16_bf16 v[144:159], v[60:63], v[56:59], v[144:159]
    ds_read_b64_tr_b16 v[42:43], v19 offset:0
    ds_read_b128 v[36:39], v14 offset:10240
    v_mfma_f32_32x32x16_bf16 v[112:127], v[64:67], v[52:55], v[112:127]
    ds_read_b64_tr_b16 v[44:45], v20 offset:0
    ds_read_b64_tr_b16 v[46:47], v21 offset:0
    v_mfma_f32_32x32x16_bf16 v[160:175], v[64:67], v[56:59], v[160:175]
    ds_read_b64_tr_b16 v[48:49], v22 offset:0
    ds_read_b64_tr_b16 v[50:51], v23 offset:0
    v_mfma_f32_32x32x16_bf16 v[128:143], v[68:71], v[52:55], v[128:143]
    v_add_u32 v17, s68, v7
    s_add_u32 s65, s65, 1
    s_cmp_lt_u32 s65, 10
    v_mfma_f32_32x32x16_bf16 v[176:191], v[68:71], v[56:59], v[176:191]
    s_cbranch_scc1 P1_N
    s_waitcnt lgkmcnt(0)
    s_nop 7
    s_branch P1D_N
P1SB_N:
    s_cmp_eq_u32 s65, 9
    s_cbranch_scc1 P1NB_N
    s_mov_b64 exec, 1
    ds_add_u32 v234, v235 offset:112
    s_mov_b64 exec, -1
    s_mov_b32 s86, 0
LW_SBN:
    ds_read_b32 v2, v234 offset:112
    s_add_u32 s86, s86, 1
    s_waitcnt lgkmcnt(0)
    v_readfirstlane_b32 s64, v2
    s_cmp_gt_u32 s86, 1600000
    s_cbranch_scc1 LWD_SBN
    s_cmp_ge_u32 s64, 8
    s_cbranch_scc1 LWD_SBN
    s_sleep 0
    s_branch LW_SBN
LWD_SBN:
    s_branch P1NB_N
P1D_N:
    s_bitcmp1_b32 s53, 0
    s_cbranch_scc0 GA_E0
    v_cvt_pk_bf16_f32 v96, v96, v97
    v_cvt_pk_bf16_f32 v97, v98, v99
    v_cvt_pk_bf16_f32 v98, v100, v101
    v_cvt_pk_bf16_f32 v99, v102, v103
    v_cvt_pk_bf16_f32 v100, v104, v105
    v_cvt_pk_bf16_f32 v101, v106, v107
    v_cvt_pk_bf16_f32 v102, v108, v109
    v_cvt_pk_bf16_f32 v103, v110, v111
    v_cvt_pk_bf16_f32 v104, v112, v113
    v_cvt_pk_bf16_f32 v105, v114, v115
    v_cvt_pk_bf16_f32 v106, v116, v117
    v_cvt_pk_bf16_f32 v107, v118, v119
    v_cvt_pk_bf16_f32 v108, v120, v121
    v_cvt_pk_bf16_f32 v109, v122, v123
    v_cvt_pk_bf16_f32 v110, v124, v125
    v_cvt_pk_bf16_f32 v111, v126, v127
    v_cvt_pk_bf16_f32 v112, v128, v129
    v_cvt_pk_bf16_f32 v113, v130, v131
    v_cvt_pk_bf16_f32 v114, v132, v133
    v_cvt_pk_bf16_f32 v115, v134, v135
    v_cvt_pk_bf16_f32 v116, v136, v137
    v_cvt_pk_bf16_f32 v117, v138, v139
    v_cvt_pk_bf16_f32 v118, v140, v141
    v_cvt_pk_bf16_f32 v119, v142, v143
    ds_write_b64 v238, v[96:97] offset:2048
    ds_write_b64 v238, v[98:99] offset:2560
    ds_write_b64 v238, v[100:101] offset:3072
    ds_write_b64 v238, v[102:103] offset:3584
    ds_write_b64 v238, v[104:105] offset:4096
    ds_write_b64 v238, v[106:107] offset:4608
    ds_write_b64 v238, v[108:109] offset:5120
    ds_write_b64 v238, v[110:111] offset:5632
    ds_write_b64 v238, v[112:113] offset:6144
    ds_write_b64 v238, v[114:115] offset:6656
    ds_write_b64 v238, v[116:117] offset:7168
    ds_write_b64 v238, v[118:119] offset:7680
    v_cvt_pk_bf16_f32 v144, v144, v145
    v_cvt_pk_bf16_f32 v145, v146, v147
    v_cvt_pk_bf16_f32 v146, v148, v149
    v_cvt_pk_bf16_f32 v147, v150, v151
    v_cvt_pk_bf16_f32 v148, v152, v153
    v_cvt_pk_bf16_f32 v149, v154, v155
    v_cvt_pk_bf16_f32 v150, v156, v157
    v_cvt_pk_bf16_f32 v151, v158, v159
    v_cvt_pk_bf16_f32 v152, v160, v161
    v_cvt_pk_bf16_f32 v153, v162, v163
    v_cvt_pk_bf16_f32 v154, v164, v165
    v_cvt_pk_bf16_f32 v155, v166, v167
    v_cvt_pk_bf16_f32 v156, v168, v169
    v_cvt_pk_bf16_f32 v157, v170, v171
    v_cvt_pk_bf16_f32 v158, v172, v173
    v_cvt_pk_bf16_f32 v159, v174, v175
    v_cvt_pk_bf16_f32 v160, v176, v177
    v_cvt_pk_bf16_f32 v161, v178, v179
    v_cvt_pk_bf16_f32 v162, v180, v181
    v_cvt_pk_bf16_f32 v163, v182, v183
    v_cvt_pk_bf16_f32 v164, v184, v185
    v_cvt_pk_bf16_f32 v165, v186, v187
    v_cvt_pk_bf16_f32 v166, v188, v189
    v_cvt_pk_bf16_f32 v167, v190, v191
    ds_write_b64 v238, v[144:145] offset:10240
    ds_write_b64 v238, v[146:147] offset:10752
    ds_write_b64 v238, v[148:149] offset:11264
    ds_write_b64 v238, v[150:151] offset:11776
    ds_write_b64 v238, v[152:153] offset:12288
    ds_write_b64 v238, v[154:155] offset:12800
    ds_write_b64 v238, v[156:157] offset:13312
    ds_write_b64 v238, v[158:159] offset:13824
    ds_write_b64 v238, v[160:161] offset:14336
    ds_write_b64 v238, v[162:163] offset:14848
    ds_write_b64 v238, v[164:165] offset:15360
    ds_write_b64 v238, v[166:167] offset:15872
    s_branch GA_E1
GA_E0:
    v_cvt_pk_bf16_f32 v128, v128, v129
    v_cvt_pk_bf16_f32 v129, v130, v131
    v_cvt_pk_bf16_f32 v130, v132, v133
    v_cvt_pk_bf16_f32 v131, v134, v135
    v_cvt_pk_bf16_f32 v132, v136, v137
    v_cvt_pk_bf16_f32 v133, v138, v139
    v_cvt_pk_bf16_f32 v134, v140, v141
    v_cvt_pk_bf16_f32 v135, v142, v143
    v_cvt_pk_bf16_f32 v176, v176, v177
    v_cvt_pk_bf16_f32 v177, v178, v179
    v_cvt_pk_bf16_f32 v178, v180, v181
    v_cvt_pk_bf16_f32 v179, v182, v183
    v_cvt_pk_bf16_f32 v180, v184, v185
    v_cvt_pk_bf16_f32 v181, v186, v187
    v_cvt_pk_bf16_f32 v182, v188, v189
    v_cvt_pk_bf16_f32 v183, v190, v191
    ds_write_b64 v238, v[128:129] offset:0
    ds_write_b64 v238, v[130:131] offset:512
    ds_write_b64 v238, v[132:133] offset:1024
    ds_write_b64 v238, v[134:135] offset:1536
    ds_write_b64 v238, v[176:177] offset:8192
    ds_write_b64 v238, v[178:179] offset:8704
    ds_write_b64 v238, v[180:181] offset:9216
    ds_write_b64 v238, v[182:183] offset:9728
GA_E0Q:
    v_mul_f32 v8, 0xbfb8aa3b, v116
    v_mul_f32 v10, 0xbfb8aa3b, v164
    v_exp_f32 v8, v8
    v_exp_f32 v10, v10
    s_mov_b32 s76, 0x3ea52b5c
    s_mov_b32 s77, s76
    v_pk_mul_f32 v[144:145], v[144:145], s[76:77]
    v_pk_mul_f32 v[146:147], v[146:147], s[76:77]
    v_pk_mul_f32 v[148:149], v[148:149], s[76:77]
    v_pk_mul_f32 v[150:151], v[150:151], s[76:77]
    v_pk_mul_f32 v[152:153], v[152:153], s[76:77]
    v_pk_mul_f32 v[154:155], v[154:155], s[76:77]
    v_pk_mul_f32 v[156:157], v[156:157], s[76:77]
    v_pk_mul_f32 v[158:159], v[158:159], s[76:77]
    v_pk_mul_f32 v[160:161], v[160:161], s[76:77]
    v_pk_mul_f32 v[162:163], v[162:163], s[76:77]
    v_cvt_pk_bf16_f32 v144, v144, v145
    v_cvt_pk_bf16_f32 v145, v146, v147
    v_cvt_pk_bf16_f32 v146, v148, v149
    v_cvt_pk_bf16_f32 v147, v150, v151
    v_cvt_pk_bf16_f32 v148, v152, v153
    v_cvt_pk_bf16_f32 v149, v154, v155
    v_cvt_pk_bf16_f32 v150, v156, v157
    v_cvt_pk_bf16_f32 v151, v158, v159
    v_cvt_pk_bf16_f32 v152, v160, v161
    v_cvt_pk_bf16_f32 v153, v162, v163
    v_add_f32 v8, 1.0, v8
    v_add_f32 v10, 1.0, v10
    v_rcp_f32 v237, v8
    v_rcp_f32 v10, v10
    ds_write_b128 v239, v[144:147]
    ds_write_b128 v239, v[148:151] offset:1024
    ds_write_b64 v240, v[152:153] offset:2048
    ds_write_b32 v241, v237
    ds_write_b32 v241, v10 offset:128
    v_pk_mul_f32 v[96:97], v[96:97], s[76:77]
    v_pk_mul_f32 v[98:99], v[98:99], s[76:77]
    v_pk_mul_f32 v[100:101], v[100:101], s[76:77]
    v_pk_mul_f32 v[102:103], v[102:103], s[76:77]
    v_pk_mul_f32 v[104:105], v[104:105], s[76:77]
    v_pk_mul_f32 v[106:107], v[106:107], s[76:77]
    v_pk_mul_f32 v[108:109], v[108:109], s[76:77]
    v_pk_mul_f32 v[110:111], v[110:111], s[76:77]
    v_pk_mul_f32 v[112:113], v[112:113], s[76:77]
    v_pk_mul_f32 v[114:115], v[114:115], s[76:77]
    v_cvt_pk_bf16_f32 v20, v96, v97
    v_cvt_pk_bf16_f32 v21, v98, v99
    v_cvt_pk_bf16_f32 v22, v100, v101
    v_cvt_pk_bf16_f32 v23, v102, v103
    v_cvt_pk_bf16_f32 v24, v104, v105
    v_cvt_pk_bf16_f32 v25, v106, v107
    v_cvt_pk_bf16_f32 v26, v108, v109
    v_cvt_pk_bf16_f32 v27, v110, v111
    v_cvt_pk_bf16_f32 v28, v112, v113
    v_cvt_pk_bf16_f32 v29, v114, v115
GA_E1:
    s_waitcnt lgkmcnt(0)
    s_barrier
GA_BKD:
    ds_read_b128 v[32:35], v227
    s_bitcmp1_b32 s53, 0
    s_cbranch_scc0 GA_NOQ
    ds_read_b128 v[20:23], v239
    ds_read_b128 v[24:27], v239 offset:1024
    ds_read_b64 v[28:29], v240 offset:2048
    ds_read_b32 v237, v241
    s_mov_b64 s[72:73], exec
    s_and_b64 exec, exec, 1
    ds_add_u32 v234, v235 offset:96
    s_mov_b64 exec, s[72:73]
GA_NOQ:
    ds_read_b64 v[40:41], v228 offset:4096
    ds_read_b128 v[36:39], v227 offset:1024
    ds_read_b64 v[42:43], v228 offset:4352
    ds_read_b128 v[44:47], v229 offset:5120
    ds_read_b128 v[48:51], v229 offset:5824
    s_waitcnt lgkmcnt(5)
    v_mfma_f32_32x32x16_bf16 v[64:79], v[32:35], v[20:23], 0
    v_mfma_f32_32x32x16_bf16 v[80:95], v[32:35], v[24:27], 0
    s_waitcnt lgkmcnt(4)
    s_nop 8
    v_mfma_f32_32x32x4_2b_bf16 v[96:127], v[40:41], v[28:29], v[64:95]
    s_nop 0
    v_max3_f32 v2, v64, v65, v66
    v_max3_f32 v3, v80, v81, v82
    v_max3_f32 v2, v2, v67, v68
    v_max3_f32 v3, v3, v83, v84
    v_max3_f32 v2, v2, v69, v70
    v_max3_f32 v3, v3, v85, v86
    v_max3_f32 v2, v2, v71, v72
    v_max3_f32 v3, v3, v87, v88
    v_max3_f32 v2, v2, v73, v74
    v_max3_f32 v3, v3, v89, v90
    v_max3_f32 v2, v2, v75, v76
    v_max3_f32 v3, v3, v91, v92
    v_max3_f32 v2, v2, v77, v78
    v_max3_f32 v3, v3, v93, v94
    v_max_f32 v2, v2, v79
    v_max_f32 v3, v3, v95
    v_mov_b32 v4, v2
    v_mov_b32 v5, v3
    s_nop 0
    v_permlane32_swap_b32 v4, v2
    v_permlane32_swap_b32 v5, v3
    s_nop 0
    v_min_f32 v128, -v2, -v4
    v_min_f32 v129, -v2, -v4
    v_min_f32 v144, -v3, -v5
    v_min_f32 v145, -v3, -v5
    v_pk_add_f32 v[64:65], v[96:97], v[128:129]
    v_pk_add_f32 v[66:67], v[98:99], v[128:129]
    v_pk_add_f32 v[68:69], v[100:101], v[128:129]
    v_pk_add_f32 v[70:71], v[102:103], v[128:129]
    v_pk_add_f32 v[72:73], v[104:105], v[128:129]
    v_pk_add_f32 v[74:75], v[106:107], v[128:129]
    v_pk_add_f32 v[76:77], v[108:109], v[128:129]
    v_pk_add_f32 v[78:79], v[110:111], v[128:129]
    v_pk_add_f32 v[80:81], v[112:113], v[144:145]
    v_pk_add_f32 v[82:83], v[114:115], v[144:145]
    v_pk_add_f32 v[84:85], v[116:117], v[144:145]
    v_pk_add_f32 v[86:87], v[118:119], v[144:145]
    v_pk_add_f32 v[88:89], v[120:121], v[144:145]
    v_pk_add_f32 v[90:91], v[122:123], v[144:145]
    v_pk_add_f32 v[92:93], v[124:125], v[144:145]
    v_pk_add_f32 v[94:95], v[126:127], v[144:145]
    v_mov_b64 v[130:131], v[128:129]
    v_mov_b64 v[132:133], v[128:129]
    v_mov_b64 v[134:135], v[128:129]
    v_mov_b64 v[136:137], v[128:129]
    v_mov_b64 v[138:139], v[128:129]
    v_mov_b64 v[140:141], v[128:129]
    v_mov_b64 v[142:143], v[128:129]
    v_mov_b64 v[146:147], v[144:145]
    v_mov_b64 v[148:149], v[144:145]
    v_mov_b64 v[150:151], v[144:145]
    v_mov_b64 v[152:153], v[144:145]
    v_mov_b64 v[154:155], v[144:145]
    v_mov_b64 v[156:157], v[144:145]
    v_mov_b64 v[158:159], v[144:145]
    s_mov_b32 s67, 0
    s_mov_b32 s63, 4
    v_exp_f32 v64, v64
    v_exp_f32 v65, v65
    s_branch GA_ENTRY
.p2align 3
GA_LOOP:
    v_exp_f32 v64, v64
    v_exp_f32 v65, v65
    v_smfmac_f32_32x32x32_bf16 v[208:223], v[56:59], v[120:127], v233
GA_ENTRY:
    v_exp_f32 v66, v66
    v_exp_f32 v67, v67
    v_exp_f32 v68, v68
    s_waitcnt lgkmcnt(0)
    v_mfma_f32_32x32x4_2b_bf16 v[96:127], v[42:43], v[28:29], v[128:159]
    ds_read_b128 v[52:55], v229 offset:6528
    ds_read_b128 v[56:59], v229 offset:7232
    ds_read_b128 v[32:35], v227 offset:2048
    ds_read_b64 v[40:41], v228 offset:4608
    v_exp_f32 v69, v69
    v_exp_f32 v70, v70
    v_exp_f32 v71, v71
    v_exp_f32 v72, v72
    v_exp_f32 v73, v73
    v_exp_f32 v74, v74
    v_exp_f32 v75, v75
    v_exp_f32 v76, v76
    v_smfmac_f32_32x32x32_bf16 v[192:207], v[44:47], v[64:71], v233
    v_exp_f32 v77, v77
    v_exp_f32 v78, v78
    v_exp_f32 v79, v79
    v_exp_f32 v80, v80
    v_exp_f32 v81, v81
    v_smfmac_f32_32x32x32_bf16 v[192:207], v[48:51], v[72:79], v233
    v_exp_f32 v82, v82
    v_exp_f32 v83, v83
    v_exp_f32 v84, v84
    v_exp_f32 v85, v85
    v_mfma_f32_32x32x16_bf16 v[96:111], v[36:39], v[20:23], v[96:111]
    v_exp_f32 v86, v86
    v_exp_f32 v87, v87
    v_exp_f32 v88, v88
    v_exp_f32 v89, v89
    v_smfmac_f32_32x32x32_bf16 v[208:223], v[44:47], v[80:87], v233
    v_exp_f32 v90, v90
    v_exp_f32 v91, v91
    v_exp_f32 v92, v92
    v_mfma_f32_32x32x16_bf16 v[112:127], v[36:39], v[24:27], v[112:127]
    v_exp_f32 v93, v93
    v_exp_f32 v94, v94
    v_exp_f32 v95, v95
    v_exp_f32 v96, v96
    v_exp_f32 v97, v97
    v_smfmac_f32_32x32x32_bf16 v[208:223], v[48:51], v[88:95], v233
    v_exp_f32 v98, v98
    v_exp_f32 v99, v99
    v_exp_f32 v100, v100
    s_waitcnt lgkmcnt(0)
    v_mfma_f32_32x32x4_2b_bf16 v[64:95], v[40:41], v[28:29], v[128:159]
    ds_read_b128 v[44:47], v229 offset:7936
    ds_read_b128 v[48:51], v229 offset:8640
    ds_read_b128 v[36:39], v227 offset:3072
    ds_read_b64 v[42:43], v228 offset:4864
    v_exp_f32 v101, v101
    v_exp_f32 v102, v102
    v_exp_f32 v103, v103
    v_exp_f32 v104, v104
    v_exp_f32 v105, v105
    v_exp_f32 v106, v106
    v_exp_f32 v107, v107
    v_exp_f32 v108, v108
    v_smfmac_f32_32x32x32_bf16 v[192:207], v[52:55], v[96:103], v233
    v_exp_f32 v109, v109
    v_exp_f32 v110, v110
    v_exp_f32 v111, v111
    v_exp_f32 v112, v112
    v_exp_f32 v113, v113
    v_smfmac_f32_32x32x32_bf16 v[192:207], v[56:59], v[104:111], v233
    v_exp_f32 v114, v114
    v_exp_f32 v115, v115
    v_exp_f32 v116, v116
    v_exp_f32 v117, v117
    v_mfma_f32_32x32x16_bf16 v[64:79], v[32:35], v[20:23], v[64:79]
    v_exp_f32 v118, v118
    v_exp_f32 v119, v119
    v_exp_f32 v120, v120
    v_exp_f32 v121, v121
    v_smfmac_f32_32x32x32_bf16 v[208:223], v[52:55], v[112:119], v233
    v_exp_f32 v122, v122
    v_exp_f32 v123, v123
    v_exp_f32 v124, v124
    v_mfma_f32_32x32x16_bf16 v[80:95], v[32:35], v[24:27], v[80:95]
    v_exp_f32 v125, v125
    v_exp_f32 v126, v126
    v_exp_f32 v127, v127
    v_exp_f32 v64, v64
    v_exp_f32 v65, v65
    v_smfmac_f32_32x32x32_bf16 v[208:223], v[56:59], v[120:127], v233
    v_exp_f32 v66, v66
    v_exp_f32 v67, v67
    v_exp_f32 v68, v68
    s_waitcnt lgkmcnt(0)
    v_mfma_f32_32x32x4_2b_bf16 v[96:127], v[42:43], v[28:29], v[128:159]
    ds_read_b128 v[52:55], v229 offset:9344
    ds_read_b128 v[56:59], v229 offset:10048
    ds_read_b128 v[32:35], v227 offset:10752
    ds_read_b64 v[40:41], v228 offset:14848
    v_exp_f32 v69, v69
    v_exp_f32 v70, v70
    v_exp_f32 v71, v71
    v_exp_f32 v72, v72
    v_exp_f32 v73, v73
    v_exp_f32 v74, v74
    v_exp_f32 v75, v75
    v_exp_f32 v76, v76
    v_smfmac_f32_32x32x32_bf16 v[192:207], v[44:47], v[64:71], v233
    v_exp_f32 v77, v77
    v_exp_f32 v78, v78
    v_exp_f32 v79, v79
    v_exp_f32 v80, v80
    v_exp_f32 v81, v81
    v_smfmac_f32_32x32x32_bf16 v[192:207], v[48:51], v[72:79], v233
    v_exp_f32 v82, v82
    v_exp_f32 v83, v83
    v_exp_f32 v84, v84
    v_exp_f32 v85, v85
    v_mfma_f32_32x32x16_bf16 v[96:111], v[36:39], v[20:23], v[96:111]
    v_exp_f32 v86, v86
    v_exp_f32 v87, v87
    v_exp_f32 v88, v88
    v_exp_f32 v89, v89
    v_smfmac_f32_32x32x32_bf16 v[208:223], v[44:47], v[80:87], v233
    v_exp_f32 v90, v90
    v_exp_f32 v91, v91
    v_exp_f32 v92, v92
    v_mfma_f32_32x32x16_bf16 v[112:127], v[36:39], v[24:27], v[112:127]
    v_exp_f32 v93, v93
    v_exp_f32 v94, v94
    v_exp_f32 v95, v95
    v_exp_f32 v96, v96
    v_exp_f32 v97, v97
    v_smfmac_f32_32x32x32_bf16 v[208:223], v[48:51], v[88:95], v233
    v_exp_f32 v98, v98
    v_exp_f32 v99, v99
    v_exp_f32 v100, v100
    s_waitcnt lgkmcnt(0)
    v_mfma_f32_32x32x4_2b_bf16 v[64:95], v[40:41], v[28:29], v[128:159]
    ds_read_b128 v[44:47], v229 offset:15872
    ds_read_b128 v[48:51], v229 offset:16576
    ds_read_b128 v[36:39], v227 offset:11776
    ds_read_b64 v[42:43], v228 offset:15104
    v_exp_f32 v101, v101
    v_exp_f32 v102, v102
    v_exp_f32 v103, v103
    v_exp_f32 v104, v104
    v_exp_f32 v105, v105
    v_exp_f32 v106, v106
    v_exp_f32 v107, v107
    v_exp_f32 v108, v108
    v_smfmac_f32_32x32x32_bf16 v[192:207], v[52:55], v[96:103], v233
    v_exp_f32 v109, v109
    v_exp_f32 v110, v110
    v_exp_f32 v111, v111
    v_exp_f32 v112, v112
    v_exp_f32 v113, v113
    v_smfmac_f32_32x32x32_bf16 v[192:207], v[56:59], v[104:111], v233
    v_exp_f32 v114, v114
    v_exp_f32 v115, v115
    v_exp_f32 v116, v116
    v_exp_f32 v117, v117
    v_mfma_f32_32x32x16_bf16 v[64:79], v[32:35], v[20:23], v[64:79]
    v_exp_f32 v118, v118
    v_exp_f32 v119, v119
    v_exp_f32 v120, v120
    v_exp_f32 v121, v121
    v_smfmac_f32_32x32x32_bf16 v[208:223], v[52:55], v[112:119], v233
    v_exp_f32 v122, v122
    v_exp_f32 v123, v123
    v_exp_f32 v124, v124
    v_mfma_f32_32x32x16_bf16 v[80:95], v[32:35], v[24:27], v[80:95]
    v_exp_f32 v125, v125
    v_exp_f32 v126, v126
    v_exp_f32 v127, v127
    v_exp_f32 v64, v64
    v_exp_f32 v65, v65
    v_smfmac_f32_32x32x32_bf16 v[208:223], v[56:59], v[120:127], v233
    v_exp_f32 v66, v66
    v_exp_f32 v67, v67
    v_exp_f32 v68, v68
    s_waitcnt lgkmcnt(0)
    v_mfma_f32_32x32x4_2b_bf16 v[96:127], v[42:43], v[28:29], v[128:159]
    ds_read_b128 v[52:55], v229 offset:17280
    ds_read_b128 v[56:59], v229 offset:17984
    ds_read_b128 v[32:35], v227 offset:12800
    ds_read_b64 v[40:41], v228 offset:15360
    v_exp_f32 v69, v69
    v_exp_f32 v70, v70
    v_exp_f32 v71, v71
    v_exp_f32 v72, v72
    v_exp_f32 v73, v73
    v_exp_f32 v74, v74
    v_exp_f32 v75, v75
    v_exp_f32 v76, v76
    v_smfmac_f32_32x32x32_bf16 v[192:207], v[44:47], v[64:71], v233
    v_exp_f32 v77, v77
    v_exp_f32 v78, v78
    v_exp_f32 v79, v79
    v_exp_f32 v80, v80
    v_exp_f32 v81, v81
    v_smfmac_f32_32x32x32_bf16 v[192:207], v[48:51], v[72:79], v233
    v_exp_f32 v82, v82
    v_exp_f32 v83, v83
    v_exp_f32 v84, v84
    v_exp_f32 v85, v85
    v_mfma_f32_32x32x16_bf16 v[96:111], v[36:39], v[20:23], v[96:111]
    v_exp_f32 v86, v86
    v_exp_f32 v87, v87
    v_exp_f32 v88, v88
    v_exp_f32 v89, v89
    v_smfmac_f32_32x32x32_bf16 v[208:223], v[44:47], v[80:87], v233
    v_exp_f32 v90, v90
    v_exp_f32 v91, v91
    v_exp_f32 v92, v92
    v_mfma_f32_32x32x16_bf16 v[112:127], v[36:39], v[24:27], v[112:127]
    v_exp_f32 v93, v93
    v_exp_f32 v94, v94
    v_exp_f32 v95, v95
    v_exp_f32 v96, v96
    v_exp_f32 v97, v97
    v_smfmac_f32_32x32x32_bf16 v[208:223], v[48:51], v[88:95], v233
    v_exp_f32 v98, v98
    v_exp_f32 v99, v99
    v_exp_f32 v100, v100
    s_waitcnt lgkmcnt(0)
    v_mfma_f32_32x32x4_2b_bf16 v[64:95], v[40:41], v[28:29], v[128:159]
    ds_read_b128 v[44:47], v229 offset:18688
    ds_read_b128 v[48:51], v229 offset:19392
    ds_read_b128 v[36:39], v227 offset:13824
    ds_read_b64 v[42:43], v228 offset:15616
    v_exp_f32 v101, v101
    v_exp_f32 v102, v102
    v_exp_f32 v103, v103
    v_exp_f32 v104, v104
    v_exp_f32 v105, v105
    v_exp_f32 v106, v106
    v_exp_f32 v107, v107
    v_exp_f32 v108, v108
    v_smfmac_f32_32x32x32_bf16 v[192:207], v[52:55], v[96:103], v233
    v_exp_f32 v109, v109
    v_exp_f32 v110, v110
    v_exp_f32 v111, v111
    v_exp_f32 v112, v112
    v_exp_f32 v113, v113
    v_smfmac_f32_32x32x32_bf16 v[192:207], v[56:59], v[104:111], v233
    v_exp_f32 v114, v114
    v_exp_f32 v115, v115
    v_exp_f32 v116, v116
    v_exp_f32 v117, v117
    v_mfma_f32_32x32x16_bf16 v[64:79], v[32:35], v[20:23], v[64:79]
    v_exp_f32 v118, v118
    v_exp_f32 v119, v119
    v_exp_f32 v120, v120
    v_exp_f32 v121, v121
    v_smfmac_f32_32x32x32_bf16 v[208:223], v[52:55], v[112:119], v233
    v_exp_f32 v122, v122
    v_exp_f32 v123, v123
    v_exp_f32 v124, v124
    v_mfma_f32_32x32x16_bf16 v[80:95], v[32:35], v[24:27], v[80:95]
    v_exp_f32 v125, v125
    v_exp_f32 v126, v126
    v_exp_f32 v127, v127
    v_exp_f32 v64, v64
    v_exp_f32 v65, v65
    v_smfmac_f32_32x32x32_bf16 v[208:223], v[56:59], v[120:127], v233
    v_exp_f32 v66, v66
    v_exp_f32 v67, v67
    v_exp_f32 v68, v68
    s_waitcnt lgkmcnt(0)
    v_mfma_f32_32x32x4_2b_bf16 v[96:127], v[42:43], v[28:29], v[128:159]
    ds_read_b128 v[52:55], v229 offset:20096
    ds_read_b128 v[56:59], v229 offset:20800
    ds_read_b128 v[32:35], v227 offset:21504
    ds_read_b64 v[40:41], v228 offset:25600
    v_exp_f32 v69, v69
    v_exp_f32 v70, v70
    v_exp_f32 v71, v71
    v_exp_f32 v72, v72
    v_exp_f32 v73, v73
    v_exp_f32 v74, v74
    v_exp_f32 v75, v75
    v_exp_f32 v76, v76
    v_smfmac_f32_32x32x32_bf16 v[192:207], v[44:47], v[64:71], v233
    v_exp_f32 v77, v77
    v_exp_f32 v78, v78
    v_exp_f32 v79, v79
    v_exp_f32 v80, v80
    v_exp_f32 v81, v81
    v_smfmac_f32_32x32x32_bf16 v[192:207], v[48:51], v[72:79], v233
    v_exp_f32 v82, v82
    v_exp_f32 v83, v83
    v_exp_f32 v84, v84
    v_exp_f32 v85, v85
    v_mfma_f32_32x32x16_bf16 v[96:111], v[36:39], v[20:23], v[96:111]
    v_exp_f32 v86, v86
    v_exp_f32 v87, v87
    v_exp_f32 v88, v88
    v_exp_f32 v89, v89
    v_smfmac_f32_32x32x32_bf16 v[208:223], v[44:47], v[80:87], v233
    v_exp_f32 v90, v90
    v_exp_f32 v91, v91
    v_exp_f32 v92, v92
    v_mfma_f32_32x32x16_bf16 v[112:127], v[36:39], v[24:27], v[112:127]
    v_exp_f32 v93, v93
    v_exp_f32 v94, v94
    v_exp_f32 v95, v95
    v_exp_f32 v96, v96
    v_exp_f32 v97, v97
    v_smfmac_f32_32x32x32_bf16 v[208:223], v[48:51], v[88:95], v233
    v_exp_f32 v98, v98
    v_exp_f32 v99, v99
    v_exp_f32 v100, v100
    s_waitcnt lgkmcnt(0)
    v_mfma_f32_32x32x4_2b_bf16 v[64:95], v[40:41], v[28:29], v[128:159]
    ds_read_b128 v[44:47], v229 offset:26624
    ds_read_b128 v[48:51], v229 offset:27328
    ds_read_b128 v[36:39], v227 offset:22528
    ds_read_b64 v[42:43], v228 offset:25856
    v_exp_f32 v101, v101
    v_exp_f32 v102, v102
    v_exp_f32 v103, v103
    v_exp_f32 v104, v104
    v_exp_f32 v105, v105
    v_exp_f32 v106, v106
    v_exp_f32 v107, v107
    v_exp_f32 v108, v108
    v_smfmac_f32_32x32x32_bf16 v[192:207], v[52:55], v[96:103], v233
    v_exp_f32 v109, v109
    v_exp_f32 v110, v110
    v_exp_f32 v111, v111
    v_exp_f32 v112, v112
    v_exp_f32 v113, v113
    v_smfmac_f32_32x32x32_bf16 v[192:207], v[56:59], v[104:111], v233
    v_exp_f32 v114, v114
    v_exp_f32 v115, v115
    v_exp_f32 v116, v116
    v_exp_f32 v117, v117
    v_mfma_f32_32x32x16_bf16 v[64:79], v[32:35], v[20:23], v[64:79]
    v_exp_f32 v118, v118
    v_exp_f32 v119, v119
    v_exp_f32 v120, v120
    v_exp_f32 v121, v121
    v_smfmac_f32_32x32x32_bf16 v[208:223], v[52:55], v[112:119], v233
    v_exp_f32 v122, v122
    v_exp_f32 v123, v123
    v_exp_f32 v124, v124
    v_mfma_f32_32x32x16_bf16 v[80:95], v[32:35], v[24:27], v[80:95]
    v_exp_f32 v125, v125
    v_exp_f32 v126, v126
    v_exp_f32 v127, v127
    v_exp_f32 v64, v64
    v_exp_f32 v65, v65
    v_smfmac_f32_32x32x32_bf16 v[208:223], v[56:59], v[120:127], v233
    v_exp_f32 v66, v66
    v_exp_f32 v67, v67
    v_exp_f32 v68, v68
    s_waitcnt lgkmcnt(0)
    v_mfma_f32_32x32x4_2b_bf16 v[96:127], v[42:43], v[28:29], v[128:159]
    ds_read_b128 v[52:55], v229 offset:28032
    ds_read_b128 v[56:59], v229 offset:28736
    ds_read_b128 v[32:35], v227 offset:23552
    ds_read_b64 v[40:41], v228 offset:26112
    ds_read_b32 v236, v234 offset:16
    v_exp_f32 v69, v69
    v_exp_f32 v70, v70
    v_exp_f32 v71, v71
    v_exp_f32 v72, v72
    v_exp_f32 v73, v73
    v_exp_f32 v74, v74
    v_exp_f32 v75, v75
    v_exp_f32 v76, v76
    v_smfmac_f32_32x32x32_bf16 v[192:207], v[44:47], v[64:71], v233
    v_exp_f32 v77, v77
    v_exp_f32 v78, v78
    v_exp_f32 v79, v79
    v_exp_f32 v80, v80
    v_exp_f32 v81, v81
    v_smfmac_f32_32x32x32_bf16 v[192:207], v[48:51], v[72:79], v233
    v_exp_f32 v82, v82
    v_exp_f32 v83, v83
    v_exp_f32 v84, v84
    v_exp_f32 v85, v85
    v_mfma_f32_32x32x16_bf16 v[96:111], v[36:39], v[20:23], v[96:111]
    v_exp_f32 v86, v86
    v_exp_f32 v87, v87
    v_exp_f32 v88, v88
    v_exp_f32 v89, v89
    v_smfmac_f32_32x32x32_bf16 v[208:223], v[44:47], v[80:87], v233
    v_exp_f32 v90, v90
    v_exp_f32 v91, v91
    v_exp_f32 v92, v92
    v_mfma_f32_32x32x16_bf16 v[112:127], v[36:39], v[24:27], v[112:127]
    v_exp_f32 v93, v93
    v_exp_f32 v94, v94
    v_exp_f32 v95, v95
    v_exp_f32 v96, v96
    v_exp_f32 v97, v97
    v_smfmac_f32_32x32x32_bf16 v[208:223], v[48:51], v[88:95], v233
    v_exp_f32 v98, v98
    v_exp_f32 v99, v99
    v_exp_f32 v100, v100
    s_waitcnt lgkmcnt(0)
    v_mfma_f32_32x32x4_2b_bf16 v[64:95], v[40:41], v[28:29], v[128:159]
    ds_read_b128 v[44:47], v229 offset:29440
    ds_read_b128 v[48:51], v229 offset:30144
    ds_read_b128 v[36:39], v227 offset:24576
    ds_read_b64 v[42:43], v228 offset:26368
    v_exp_f32 v101, v101
    v_exp_f32 v102, v102
    v_exp_f32 v103, v103
    v_exp_f32 v104, v104
    v_exp_f32 v105, v105
    v_exp_f32 v106, v106
    v_exp_f32 v107, v107
    v_exp_f32 v108, v108
    v_smfmac_f32_32x32x32_bf16 v[192:207], v[52:55], v[96:103], v233
    v_exp_f32 v109, v109
    v_exp_f32 v110, v110
    v_exp_f32 v111, v111
    v_exp_f32 v112, v112
    v_exp_f32 v113, v113
    v_smfmac_f32_32x32x32_bf16 v[192:207], v[56:59], v[104:111], v233
    v_exp_f32 v114, v114
    v_exp_f32 v115, v115
    v_exp_f32 v116, v116
    v_exp_f32 v117, v117
    v_mfma_f32_32x32x16_bf16 v[64:79], v[32:35], v[20:23], v[64:79]
    v_exp_f32 v118, v118
    v_exp_f32 v119, v119
    v_exp_f32 v120, v120
    v_exp_f32 v121, v121
    v_smfmac_f32_32x32x32_bf16 v[208:223], v[52:55], v[112:119], v233
    v_exp_f32 v122, v122
    v_exp_f32 v123, v123
    v_exp_f32 v124, v124
    v_mfma_f32_32x32x16_bf16 v[80:95], v[32:35], v[24:27], v[80:95]
    v_exp_f32 v125, v125
    v_exp_f32 v126, v126
    v_exp_f32 v127, v127
    v_readfirstlane_b32 s64, v236
    s_nop 0
    s_cmp_lt_u32 s64, s63
    s_cbranch_scc1 GA_HOOK
GA_HOOKD:
    v_exp_f32 v64, v64
    v_exp_f32 v65, v65
    v_smfmac_f32_32x32x32_bf16 v[208:223], v[56:59], v[120:127], v233
    v_exp_f32 v66, v66
    v_exp_f32 v67, v67
    v_exp_f32 v68, v68
    s_waitcnt lgkmcnt(0)
    v_mfma_f32_32x32x4_2b_bf16 v[96:127], v[42:43], v[28:29], v[128:159]
    ds_read_b128 v[52:55], v229 offset:30848
    ds_read_b128 v[56:59], v229 offset:31552
    ds_read_b128 v[32:35], v227 offset:32256
    ds_read_b64 v[40:41], v228 offset:36352
    v_exp_f32 v69, v69
    v_exp_f32 v70, v70
    v_exp_f32 v71, v71
    v_exp_f32 v72, v72
    v_exp_f32 v73, v73
    v_exp_f32 v74, v74
    v_exp_f32 v75, v75
    v_exp_f32 v76, v76
    v_smfmac_f32_32x32x32_bf16 v[192:207], v[44:47], v[64:71], v233
    v_exp_f32 v77, v77
    v_exp_f32 v78, v78
    v_exp_f32 v79, v79
    v_exp_f32 v80, v80
    v_exp_f32 v81, v81
    v_smfmac_f32_32x32x32_bf16 v[192:207], v[48:51], v[72:79], v233
    v_exp_f32 v82, v82
    v_exp_f32 v83, v83
    v_exp_f32 v84, v84
    v_exp_f32 v85, v85
    v_mfma_f32_32x32x16_bf16 v[96:111], v[36:39], v[20:23], v[96:111]
    v_exp_f32 v86, v86
    v_exp_f32 v87, v87
    v_exp_f32 v88, v88
    v_exp_f32 v89, v89
    v_smfmac_f32_32x32x32_bf16 v[208:223], v[44:47], v[80:87], v233
    v_exp_f32 v90, v90
    v_exp_f32 v91, v91
    v_exp_f32 v92, v92
    v_mfma_f32_32x32x16_bf16 v[112:127], v[36:39], v[24:27], v[112:127]
    v_exp_f32 v93, v93
    v_exp_f32 v94, v94
    v_exp_f32 v95, v95
    v_exp_f32 v96, v96
    v_exp_f32 v97, v97
    v_smfmac_f32_32x32x32_bf16 v[208:223], v[48:51], v[88:95], v233
    v_exp_f32 v98, v98
    v_exp_f32 v99, v99
    v_exp_f32 v100, v100
    s_waitcnt lgkmcnt(0)
    v_mfma_f32_32x32x4_2b_bf16 v[64:95], v[40:41], v[28:29], v[128:159]
    ds_read_b128 v[44:47], v229 offset:37376
    ds_read_b128 v[48:51], v229 offset:38080
    ds_read_b128 v[36:39], v227 offset:33280
    ds_read_b64 v[42:43], v228 offset:36608
    v_exp_f32 v101, v101
    v_exp_f32 v102, v102
    v_exp_f32 v103, v103
    v_exp_f32 v104, v104
    v_exp_f32 v105, v105
    v_exp_f32 v106, v106
    v_exp_f32 v107, v107
    v_exp_f32 v108, v108
    v_smfmac_f32_32x32x32_bf16 v[192:207], v[52:55], v[96:103], v233
    v_exp_f32 v109, v109
    v_exp_f32 v110, v110
    v_exp_f32 v111, v111
    v_exp_f32 v112, v112
    v_exp_f32 v113, v113
    v_smfmac_f32_32x32x32_bf16 v[192:207], v[56:59], v[104:111], v233
    v_exp_f32 v114, v114
    v_exp_f32 v115, v115
    v_exp_f32 v116, v116
    v_exp_f32 v117, v117
    v_mfma_f32_32x32x16_bf16 v[64:79], v[32:35], v[20:23], v[64:79]
    v_exp_f32 v118, v118
    v_exp_f32 v119, v119
    v_exp_f32 v120, v120
    v_exp_f32 v121, v121
    v_smfmac_f32_32x32x32_bf16 v[208:223], v[52:55], v[112:119], v233
    v_exp_f32 v122, v122
    v_exp_f32 v123, v123
    v_exp_f32 v124, v124
    v_mfma_f32_32x32x16_bf16 v[80:95], v[32:35], v[24:27], v[80:95]
    v_exp_f32 v125, v125
    v_exp_f32 v126, v126
    v_exp_f32 v127, v127
    v_exp_f32 v64, v64
    v_exp_f32 v65, v65
    v_smfmac_f32_32x32x32_bf16 v[208:223], v[56:59], v[120:127], v233
    v_exp_f32 v66, v66
    v_exp_f32 v67, v67
    v_exp_f32 v68, v68
    s_waitcnt lgkmcnt(0)
    v_mfma_f32_32x32x4_2b_bf16 v[96:127], v[42:43], v[28:29], v[128:159]
    ds_read_b128 v[52:55], v229 offset:38784
    ds_read_b128 v[56:59], v229 offset:39488
    ds_read_b128 v[32:35], v227 offset:34304
    ds_read_b64 v[40:41], v228 offset:36864
    v_exp_f32 v69, v69
    v_exp_f32 v70, v70
    v_exp_f32 v71, v71
    v_exp_f32 v72, v72
    v_exp_f32 v73, v73
    v_exp_f32 v74, v74
    v_exp_f32 v75, v75
    v_exp_f32 v76, v76
    v_smfmac_f32_32x32x32_bf16 v[192:207], v[44:47], v[64:71], v233
    v_exp_f32 v77, v77
    v_exp_f32 v78, v78
    v_exp_f32 v79, v79
    v_exp_f32 v80, v80
    v_exp_f32 v81, v81
    v_smfmac_f32_32x32x32_bf16 v[192:207], v[48:51], v[72:79], v233
    v_exp_f32 v82, v82
    v_exp_f32 v83, v83
    v_exp_f32 v84, v84
    v_exp_f32 v85, v85
    v_mfma_f32_32x32x16_bf16 v[96:111], v[36:39], v[20:23], v[96:111]
    v_exp_f32 v86, v86
    v_exp_f32 v87, v87
    v_exp_f32 v88, v88
    v_exp_f32 v89, v89
    v_smfmac_f32_32x32x32_bf16 v[208:223], v[44:47], v[80:87], v233
    v_exp_f32 v90, v90
    v_exp_f32 v91, v91
    v_exp_f32 v92, v92
    v_mfma_f32_32x32x16_bf16 v[112:127], v[36:39], v[24:27], v[112:127]
    v_exp_f32 v93, v93
    v_exp_f32 v94, v94
    v_exp_f32 v95, v95
    v_exp_f32 v96, v96
    v_exp_f32 v97, v97
    v_smfmac_f32_32x32x32_bf16 v[208:223], v[48:51], v[88:95], v233
    v_exp_f32 v98, v98
    v_exp_f32 v99, v99
    v_exp_f32 v100, v100
    s_waitcnt lgkmcnt(0)
    v_mfma_f32_32x32x4_2b_bf16 v[64:95], v[40:41], v[28:29], v[128:159]
    ds_read_b128 v[44:47], v229 offset:40192
    ds_read_b128 v[48:51], v229 offset:40896
    ds_read_b128 v[36:39], v227 offset:35328
    ds_read_b64 v[42:43], v228 offset:37120
    v_exp_f32 v101, v101
    v_exp_f32 v102, v102
    v_exp_f32 v103, v103
    v_exp_f32 v104, v104
    v_exp_f32 v105, v105
    v_exp_f32 v106, v106
    v_exp_f32 v107, v107
    v_exp_f32 v108, v108
    v_smfmac_f32_32x32x32_bf16 v[192:207], v[52:55], v[96:103], v233
    v_exp_f32 v109, v109
    v_exp_f32 v110, v110
    v_exp_f32 v111, v111
    v_exp_f32 v112, v112
    v_exp_f32 v113, v113
    v_smfmac_f32_32x32x32_bf16 v[192:207], v[56:59], v[104:111], v233
    v_exp_f32 v114, v114
    v_exp_f32 v115, v115
    v_exp_f32 v116, v116
    v_exp_f32 v117, v117
    v_mfma_f32_32x32x16_bf16 v[64:79], v[32:35], v[20:23], v[64:79]
    v_exp_f32 v118, v118
    v_exp_f32 v119, v119
    v_exp_f32 v120, v120
    v_exp_f32 v121, v121
    v_smfmac_f32_32x32x32_bf16 v[208:223], v[52:55], v[112:119], v233
    v_exp_f32 v122, v122
    v_exp_f32 v123, v123
    v_exp_f32 v124, v124
    v_mfma_f32_32x32x16_bf16 v[80:95], v[32:35], v[24:27], v[80:95]
    v_exp_f32 v125, v125
    v_exp_f32 v126, v126
    v_exp_f32 v127, v127
    v_exp_f32 v64, v64
    v_exp_f32 v65, v65
    v_smfmac_f32_32x32x32_bf16 v[208:223], v[56:59], v[120:127], v233
    v_exp_f32 v66, v66
    v_exp_f32 v67, v67
    v_exp_f32 v68, v68
    s_waitcnt lgkmcnt(0)
    v_mfma_f32_32x32x4_2b_bf16 v[96:127], v[42:43], v[28:29], v[128:159]
    ds_read_b128 v[52:55], v229 offset:41600
    ds_read_b128 v[56:59], v229 offset:42304
    ds_read_b128 v[32:35], v230 offset:0
    ds_read_b64 v[40:41], v231 offset:4096
    v_exp_f32 v69, v69
    v_exp_f32 v70, v70
    v_exp_f32 v71, v71
    v_exp_f32 v72, v72
    v_exp_f32 v73, v73
    v_exp_f32 v74, v74
    v_exp_f32 v75, v75
    v_exp_f32 v76, v76
    v_smfmac_f32_32x32x32_bf16 v[192:207], v[44:47], v[64:71], v233
    v_exp_f32 v77, v77
    v_exp_f32 v78, v78
    v_exp_f32 v79, v79
    v_exp_f32 v80, v80
    v_exp_f32 v81, v81
    v_smfmac_f32_32x32x32_bf16 v[192:207], v[48:51], v[72:79], v233
    v_exp_f32 v82, v82
    v_exp_f32 v83, v83
    v_exp_f32 v84, v84
    v_exp_f32 v85, v85
    v_mfma_f32_32x32x16_bf16 v[96:111], v[36:39], v[20:23], v[96:111]
    v_exp_f32 v86, v86
    v_exp_f32 v87, v87
    v_exp_f32 v88, v88
    v_exp_f32 v89, v89
    v_smfmac_f32_32x32x32_bf16 v[208:223], v[44:47], v[80:87], v233
    v_exp_f32 v90, v90
    v_exp_f32 v91, v91
    v_exp_f32 v92, v92
    v_mfma_f32_32x32x16_bf16 v[112:127], v[36:39], v[24:27], v[112:127]
    v_exp_f32 v93, v93
    v_exp_f32 v94, v94
    v_exp_f32 v95, v95
    v_exp_f32 v96, v96
    v_exp_f32 v97, v97
    v_smfmac_f32_32x32x32_bf16 v[208:223], v[48:51], v[88:95], v233
    v_exp_f32 v98, v98
    v_exp_f32 v99, v99
    v_exp_f32 v100, v100
    s_waitcnt lgkmcnt(0)
    v_mfma_f32_32x32x4_2b_bf16 v[64:95], v[40:41], v[28:29], v[128:159]
    ds_read_b128 v[44:47], v232 offset:5120
    ds_read_b128 v[48:51], v232 offset:5824
    ds_read_b128 v[36:39], v230 offset:1024
    ds_read_b64 v[42:43], v231 offset:4352
    v_exp_f32 v101, v101
    v_exp_f32 v102, v102
    v_exp_f32 v103, v103
    v_exp_f32 v104, v104
    v_exp_f32 v105, v105
    v_exp_f32 v106, v106
    v_exp_f32 v107, v107
    v_exp_f32 v108, v108
    v_smfmac_f32_32x32x32_bf16 v[192:207], v[52:55], v[96:103], v233
    v_exp_f32 v109, v109
    v_exp_f32 v110, v110
    v_exp_f32 v111, v111
    v_exp_f32 v112, v112
    v_exp_f32 v113, v113
    v_smfmac_f32_32x32x32_bf16 v[192:207], v[56:59], v[104:111], v233
    v_exp_f32 v114, v114
    v_exp_f32 v115, v115
    v_exp_f32 v116, v116
    v_exp_f32 v117, v117
    v_mfma_f32_32x32x16_bf16 v[64:79], v[32:35], v[20:23], v[64:79]
    v_exp_f32 v118, v118
    v_exp_f32 v119, v119
    v_exp_f32 v120, v120
    v_exp_f32 v121, v121
    v_smfmac_f32_32x32x32_bf16 v[208:223], v[52:55], v[112:119], v233
    v_exp_f32 v122, v122
    v_exp_f32 v123, v123
    v_exp_f32 v124, v124
    v_mfma_f32_32x32x16_bf16 v[80:95], v[32:35], v[24:27], v[80:95]
    v_exp_f32 v125, v125
    v_exp_f32 v126, v126
    v_exp_f32 v127, v127
    s_mov_b64 exec, 1
    ds_add_u32 v234, v235 offset:48
    s_mov_b64 exec, -1
    v_add_u32 v234, 4, v234
    s_add_u32 s67, s67, 1
    s_add_u32 s69, s69, 43008
    s_cmp_eq_u32 s69, 129024
    s_cselect_b32 s69, 0, s69
    v_mov_b32 v227, v230
    v_mov_b32 v228, v231
    v_mov_b32 v229, v232
    v_add_u32 v230, s69, v224
    v_add_u32 v231, s69, v225
    v_add_u32 v232, s69, v226
    s_cmp_lt_u32 s67, 3
    s_cselect_b32 s63, 4, 0
    s_cmp_lt_u32 s67, 4
    s_cbranch_scc1 GA_LOOP
    v_smfmac_f32_32x32x32_bf16 v[208:223], v[56:59], v[120:127], v233
    s_mul_i32 s70, s56, 81920
    s_add_u32 s59, s55, 16
    s_mul_i32 s59, s59, 2560
    s_add_u32 s70, s70, s59
    s_add_u32 s70, s70, 8388608
    v_sub_f32 v237, 1.0, v237
    v_mul_f32 v2, 0x1f800000, v204
    v_mov_b32 v3, 0
    v_pk_fma_f32 v[2:3], v[192:193], 0, v[2:3]
    v_pk_fma_f32 v[2:3], v[194:195], 0, v[2:3]
    v_pk_fma_f32 v[2:3], v[196:197], 0, v[2:3]
    v_pk_fma_f32 v[2:3], v[198:199], 0, v[2:3]
    v_pk_fma_f32 v[2:3], v[200:201], 0, v[2:3]
    v_pk_fma_f32 v[2:3], v[202:203], 0, v[2:3]
    v_mul_f32 v6, 0x1f800000, v220
    v_pk_fma_f32 v[2:3], v[208:209], 0, v[2:3]
    v_pk_fma_f32 v[2:3], v[210:211], 0, v[2:3]
    v_pk_fma_f32 v[2:3], v[212:213], 0, v[2:3]
    v_pk_fma_f32 v[2:3], v[214:215], 0, v[2:3]
    v_pk_fma_f32 v[2:3], v[216:217], 0, v[2:3]
    v_pk_fma_f32 v[2:3], v[218:219], 0, v[2:3]
    v_min_f32 v4, v204, v220
    v_add_f32 v2, v2, v3
    v_add_f32 v2, v2, v6
    v_mov_b32 v5, 0x1f800000
    v_cmp_ngt_f32 vcc, 1.0, v2
    v_cmp_ngt_f32 s[72:73], v4, v5
    s_nop 3
    s_or_b64 vcc, vcc, s[72:73]
    s_cbranch_vccnz GA_FALLBACK
GA_FINAL:
    v_rcp_f32 v2, v204
    v_rcp_f32 v3, v220
    s_nop 0
    v_mul_f32 v2, v2, v237
    v_mul_f32 v3, v3, v237
    v_pk_mul_f32 v[192:193], v[192:193], v[2:3] op_sel:[0,0] op_sel_hi:[1,0]
    v_pk_mul_f32 v[194:195], v[194:195], v[2:3] op_sel:[0,0] op_sel_hi:[1,0]
    v_pk_mul_f32 v[196:197], v[196:197], v[2:3] op_sel:[0,0] op_sel_hi:[1,0]
    v_pk_mul_f32 v[198:199], v[198:199], v[2:3] op_sel:[0,0] op_sel_hi:[1,0]
    v_pk_mul_f32 v[200:201], v[200:201], v[2:3] op_sel:[0,0] op_sel_hi:[1,0]
    v_pk_mul_f32 v[202:203], v[202:203], v[2:3] op_sel:[0,0] op_sel_hi:[1,0]
    v_cvt_pk_bf16_f32 v160, v192, v193
    v_cvt_pk_bf16_f32 v161, v194, v195
    v_cvt_pk_bf16_f32 v162, v196, v197
    v_cvt_pk_bf16_f32 v163, v198, v199
    v_cvt_pk_bf16_f32 v164, v200, v201
    v_cvt_pk_bf16_f32 v165, v202, v203
    buffer_store_dwordx4 v[160:163], v224, s[36:39], s70 offen offset:0 sc1
    s_mov_b32 exec_hi, 0
    buffer_store_dwordx2 v[164:165], v225, s[36:39], s70 offen offset:2048 sc1
    s_mov_b32 exec_hi, -1
    v_pk_mul_f32 v[208:209], v[208:209], v[2:3] op_sel:[0,1] op_sel_hi:[1,1]
    v_pk_mul_f32 v[210:211], v[210:211], v[2:3] op_sel:[0,1] op_sel_hi:[1,1]
    v_pk_mul_f32 v[212:213], v[212:213], v[2:3] op_sel:[0,1] op_sel_hi:[1,1]
    v_pk_mul_f32 v[214:215], v[214:215], v[2:3] op_sel:[0,1] op_sel_hi:[1,1]
    v_pk_mul_f32 v[216:217], v[216:217], v[2:3] op_sel:[0,1] op_sel_hi:[1,1]
    v_pk_mul_f32 v[218:219], v[218:219], v[2:3] op_sel:[0,1] op_sel_hi:[1,1]
    v_cvt_pk_bf16_f32 v166, v208, v209
    v_cvt_pk_bf16_f32 v167, v210, v211
    v_cvt_pk_bf16_f32 v168, v212, v213
    v_cvt_pk_bf16_f32 v169, v214, v215
    v_cvt_pk_bf16_f32 v170, v216, v217
    v_cvt_pk_bf16_f32 v171, v218, v219
    buffer_store_dwordx4 v[166:169], v224, s[36:39], s70 offen offset:1024 sc1
    s_mov_b32 exec_hi, 0
    buffer_store_dwordx2 v[170:171], v225, s[36:39], s70 offen offset:2304 sc1
    s_mov_b32 exec_hi, -1
    s_mov_b64 exec, 1
    ds_add_u32 v234, v235 offset:48
    s_mov_b64 exec, -1
    s_branch FINAL_REDUCE
GA_HOOK:
    s_mov_b32 s86, 0
LW_A:
    ds_read_b32 v2, v234 offset:16
    s_add_u32 s86, s86, 1
    s_waitcnt lgkmcnt(0)
    v_readfirstlane_b32 s64, v2
    s_cmp_gt_u32 s86, 1600000
    s_cbranch_scc1 LWD_A
    s_cmp_ge_u32 s64, 4
    s_cbranch_scc1 LWD_A
    s_sleep 2
    s_branch LW_A
LWD_A:
    s_branch GA_HOOKD
GA_SPEC0:
    s_mov_b32 s68, 0
    v_add_u32 v14, s68, v4
    v_add_u32 v15, s68, v5
    v_add_u32 v16, s68, v6
    v_add_u32 v17, s68, v7
    v_add_u32 v18, s68, v8
    v_add_u32 v19, s68, v9
    v_add_u32 v20, s68, v10
    v_add_u32 v21, s68, v11
    s_barrier
    ds_read_b128 v[32:35], v14
    ds_read_b64_tr_b16 v[40:41], v18 offset:0
    ds_read_b64_tr_b16 v[42:43], v19 offset:0
    ds_read_b128 v[36:39], v14 offset:10240
    ds_read_b64_tr_b16 v[44:45], v20 offset:0
    ds_read_b64_tr_b16 v[46:47], v21 offset:0
    s_mov_b32 s65, 0
.p2align 3
P1_S0:
    s_waitcnt lgkmcnt(3)
    v_mfma_f32_32x32x16_bf16 v[96:111], v[40:43], v[32:35], v[96:111]
    ds_read_b128 v[52:55], v15
    ds_read_b64_tr_b16 v[60:61], v18 offset:10240
    s_waitcnt lgkmcnt(4)
    v_mfma_f32_32x32x16_bf16 v[144:159], v[40:43], v[36:39], v[144:159]
    ds_read_b64_tr_b16 v[62:63], v19 offset:10240
    ds_read_b128 v[56:59], v15 offset:10240
    s_waitcnt lgkmcnt(4)
    v_mfma_f32_32x32x16_bf16 v[112:127], v[44:47], v[32:35], v[112:127]
    ds_read_b64_tr_b16 v[64:65], v20 offset:10240
    ds_read_b64_tr_b16 v[66:67], v21 offset:10240
    v_mfma_f32_32x32x16_bf16 v[160:175], v[44:47], v[36:39], v[160:175]
    s_add_u32 s68, s68, 40960
    s_cmp_ge_u32 s68, 122880
    s_cselect_b32 s68, 0, s68
    s_waitcnt lgkmcnt(3)
    v_mfma_f32_32x32x16_bf16 v[96:111], v[60:63], v[52:55], v[96:111]
    ds_read_b128 v[32:35], v16
    ds_read_b64_tr_b16 v[40:41], v18 offset:20480
    s_waitcnt lgkmcnt(4)
    v_mfma_f32_32x32x16_bf16 v[144:159], v[60:63], v[56:59], v[144:159]
    ds_read_b64_tr_b16 v[42:43], v19 offset:20480
    ds_read_b128 v[36:39], v16 offset:10240
    s_waitcnt lgkmcnt(4)
    v_mfma_f32_32x32x16_bf16 v[112:127], v[64:67], v[52:55], v[112:127]
    ds_read_b64_tr_b16 v[44:45], v20 offset:20480
    ds_read_b64_tr_b16 v[46:47], v21 offset:20480
    v_mfma_f32_32x32x16_bf16 v[160:175], v[64:67], v[56:59], v[160:175]
    v_add_u32 v14, s68, v4
    v_add_u32 v15, s68, v5
    v_add_u32 v16, s68, v6
    s_waitcnt lgkmcnt(3)
    v_mfma_f32_32x32x16_bf16 v[96:111], v[40:43], v[32:35], v[96:111]
    ds_read_b128 v[52:55], v17
    ds_read_b64_tr_b16 v[60:61], v18 offset:30720
    ds_read_b64_tr_b16 v[62:63], v19 offset:30720
    s_waitcnt lgkmcnt(5)
    v_mfma_f32_32x32x16_bf16 v[144:159], v[40:43], v[36:39], v[144:159]
    ds_read_b128 v[56:59], v17 offset:10240
    ds_read_b64_tr_b16 v[64:65], v20 offset:30720
    ds_read_b64_tr_b16 v[66:67], v21 offset:30720
    s_waitcnt lgkmcnt(6)
    v_mfma_f32_32x32x16_bf16 v[112:127], v[44:47], v[32:35], v[112:127]
    v_add_u32 v18, s68, v8
    v_add_u32 v19, s68, v9
    v_mfma_f32_32x32x16_bf16 v[160:175], v[44:47], v[36:39], v[160:175]
    v_add_u32 v20, s68, v10
    v_add_u32 v21, s68, v11
    s_cmp_ge_u32 s65, 8
    s_waitcnt lgkmcnt(0)
    v_mfma_f32_32x32x16_bf16 v[96:111], v[60:63], v[52:55], v[96:111]
    s_cbranch_scc1 P1SB_S0
    s_barrier
P1NB_S0:
    ds_read_b128 v[32:35], v14
    ds_read_b64_tr_b16 v[40:41], v18 offset:0
    v_mfma_f32_32x32x16_bf16 v[144:159], v[60:63], v[56:59], v[144:159]
    ds_read_b64_tr_b16 v[42:43], v19 offset:0
    ds_read_b128 v[36:39], v14 offset:10240
    v_mfma_f32_32x32x16_bf16 v[112:127], v[64:67], v[52:55], v[112:127]
    ds_read_b64_tr_b16 v[44:45], v20 offset:0
    ds_read_b64_tr_b16 v[46:47], v21 offset:0
    v_add_u32 v17, s68, v7
    s_add_u32 s65, s65, 1
    s_cmp_lt_u32 s65, 10
    v_mfma_f32_32x32x16_bf16 v[160:175], v[64:67], v[56:59], v[160:175]
    s_cbranch_scc1 P1_S0
    s_waitcnt lgkmcnt(0)
    s_nop 7
    s_branch P1D_S0
P1SB_S0:
    s_cmp_eq_u32 s65, 9
    s_cbranch_scc1 P1NB_S0
    s_mov_b64 exec, 1
    ds_add_u32 v234, v235 offset:112
    s_mov_b64 exec, -1
    s_mov_b32 s86, 0
LW_SBS0:
    ds_read_b32 v2, v234 offset:112
    s_add_u32 s86, s86, 1
    s_waitcnt lgkmcnt(0)
    v_readfirstlane_b32 s64, v2
    s_cmp_gt_u32 s86, 1600000
    s_cbranch_scc1 LWD_SBS0
    s_cmp_ge_u32 s64, 8
    s_cbranch_scc1 LWD_SBS0
    s_sleep 0
    s_branch LW_SBS0
LWD_SBS0:
    s_branch P1NB_S0
P1D_S0:
    s_branch GA_E0Q
GA_SPEC1:
    v_min_u32 v27, 4, v3
    v_mul_u32_u24 v28, 40, v2
    v_lshl_add_u32 v27, v27, 3, v28
    v_add_u32 v8, 40960, v27
    v_add_u32 v9, 41120, v27
    v_add_u32 v10, 41984, v27
    v_add_u32 v11, 42144, v27
    s_mov_b32 s68, 0
    v_add_u32 v14, s68, v4
    v_add_u32 v15, s68, v5
    v_add_u32 v16, s68, v6
    v_add_u32 v17, s68, v7
    v_add_u32 v18, s68, v8
    v_add_u32 v19, s68, v9
    v_add_u32 v20, s68, v10
    v_add_u32 v21, s68, v11
    s_barrier
    ds_read_b128 v[32:35], v14
    ds_read_b64_tr_b16 v[40:41], v18 offset:0
    ds_read_b64_tr_b16 v[42:43], v19 offset:0
    ds_read_b128 v[36:39], v14 offset:10240
    ds_read_b64_tr_b16 v[44:45], v20 offset:0
    ds_read_b64_tr_b16 v[46:47], v21 offset:0
    s_mov_b32 s65, 0
.p2align 3
P1_S1:
    s_waitcnt lgkmcnt(3)
    v_mfma_f32_32x32x16_bf16 v[96:111], v[40:43], v[32:35], v[96:111]
    ds_read_b128 v[52:55], v15
    ds_read_b64_tr_b16 v[60:61], v18 offset:10240
    s_waitcnt lgkmcnt(4)
    v_mfma_f32_32x32x16_bf16 v[144:159], v[40:43], v[36:39], v[144:159]
    ds_read_b64_tr_b16 v[62:63], v19 offset:10240
    ds_read_b128 v[56:59], v15 offset:10240
    s_waitcnt lgkmcnt(4)
    v_mfma_f32_32x32x16_bf16 v[112:127], v[32:35], v[44:47], v[112:127]
    ds_read_b64_tr_b16 v[64:65], v20 offset:10240
    ds_read_b64_tr_b16 v[66:67], v21 offset:10240
    v_mfma_f32_32x32x16_bf16 v[160:175], v[36:39], v[44:47], v[160:175]
    s_add_u32 s68, s68, 40960
    s_cmp_ge_u32 s68, 122880
    s_cselect_b32 s68, 0, s68
    s_waitcnt lgkmcnt(3)
    v_mfma_f32_32x32x16_bf16 v[96:111], v[60:63], v[52:55], v[96:111]
    ds_read_b128 v[32:35], v16
    ds_read_b64_tr_b16 v[40:41], v18 offset:20480
    s_waitcnt lgkmcnt(4)
    v_mfma_f32_32x32x16_bf16 v[144:159], v[60:63], v[56:59], v[144:159]
    ds_read_b64_tr_b16 v[42:43], v19 offset:20480
    ds_read_b128 v[36:39], v16 offset:10240
    s_waitcnt lgkmcnt(4)
    v_mfma_f32_32x32x16_bf16 v[112:127], v[52:55], v[64:67], v[112:127]
    ds_read_b64_tr_b16 v[44:45], v20 offset:20480
    ds_read_b64_tr_b16 v[46:47], v21 offset:20480
    v_mfma_f32_32x32x16_bf16 v[160:175], v[56:59], v[64:67], v[160:175]
    v_add_u32 v14, s68, v4
    v_add_u32 v15, s68, v5
    v_add_u32 v16, s68, v6
    s_waitcnt lgkmcnt(3)
    v_mfma_f32_32x32x16_bf16 v[96:111], v[40:43], v[32:35], v[96:111]
    ds_read_b128 v[52:55], v17
    ds_read_b64_tr_b16 v[60:61], v18 offset:30720
    ds_read_b64_tr_b16 v[62:63], v19 offset:30720
    s_waitcnt lgkmcnt(5)
    v_mfma_f32_32x32x16_bf16 v[144:159], v[40:43], v[36:39], v[144:159]
    ds_read_b128 v[56:59], v17 offset:10240
    ds_read_b64_tr_b16 v[64:65], v20 offset:30720
    ds_read_b64_tr_b16 v[66:67], v21 offset:30720
    s_waitcnt lgkmcnt(6)
    v_mfma_f32_32x32x16_bf16 v[112:127], v[32:35], v[44:47], v[112:127]
    v_add_u32 v18, s68, v8
    v_add_u32 v19, s68, v9
    v_mfma_f32_32x32x16_bf16 v[160:175], v[36:39], v[44:47], v[160:175]
    v_add_u32 v20, s68, v10
    v_add_u32 v21, s68, v11
    s_cmp_ge_u32 s65, 8
    s_waitcnt lgkmcnt(0)
    v_mfma_f32_32x32x16_bf16 v[96:111], v[60:63], v[52:55], v[96:111]
    s_cbranch_scc1 P1SB_S1
    s_barrier
P1NB_S1:
    ds_read_b128 v[32:35], v14
    ds_read_b64_tr_b16 v[40:41], v18 offset:0
    v_mfma_f32_32x32x16_bf16 v[144:159], v[60:63], v[56:59], v[144:159]
    ds_read_b64_tr_b16 v[42:43], v19 offset:0
    ds_read_b128 v[36:39], v14 offset:10240
    v_mfma_f32_32x32x16_bf16 v[112:127], v[52:55], v[64:67], v[112:127]
    ds_read_b64_tr_b16 v[44:45], v20 offset:0
    ds_read_b64_tr_b16 v[46:47], v21 offset:0
    v_add_u32 v17, s68, v7
    s_add_u32 s65, s65, 1
    s_cmp_lt_u32 s65, 10
    v_mfma_f32_32x32x16_bf16 v[160:175], v[56:59], v[64:67], v[160:175]
    s_cbranch_scc1 P1_S1
    s_waitcnt lgkmcnt(0)
    s_nop 7
    s_branch P1D_S1
P1SB_S1:
    s_cmp_eq_u32 s65, 9
    s_cbranch_scc1 P1NB_S1
    s_mov_b64 exec, 1
    ds_add_u32 v234, v235 offset:112
    s_mov_b64 exec, -1
    s_mov_b32 s86, 0
LW_SBS1:
    ds_read_b32 v2, v234 offset:112
    s_add_u32 s86, s86, 1
    s_waitcnt lgkmcnt(0)
    v_readfirstlane_b32 s64, v2
    s_cmp_gt_u32 s86, 1600000
    s_cbranch_scc1 LWD_SBS1
    s_cmp_ge_u32 s64, 8
    s_cbranch_scc1 LWD_SBS1
    s_sleep 0
    s_branch LW_SBS1
LWD_SBS1:
    s_branch P1NB_S1
P1D_S1:
    v_mov_b32 v2, 162304
    ds_read_b32 v17, v2 offset:8
    s_mul_i32 s59, s54, 10752
    s_add_u32 s59, s59, 14680064
    s_and_b32 s63, s53, 2
    s_lshl_b32 s60, s63, 10
    s_add_u32 s60, s60, s59
    s_lshl_b32 s61, s63, 8
    s_add_u32 s61, s61, s59
    s_add_u32 s61, s61, 4096
    s_mul_i32 s62, s63, 1408
    s_add_u32 s62, s62, s59
    s_add_u32 s62, s62, 5120
    v_and_b32 v3, 0x33, v1
    v_bfe_u32 v4, v1, 2, 1
    v_lshl_or_b32 v3, v4, 3, v3
    v_bfe_u32 v4, v1, 3, 1
    v_lshl_or_b32 v3, v4, 2, v3
    v_lshlrev_b32 v4, 4, v3
    v_lshlrev_b32 v5, 3, v3
    v_lshrrev_b32 v6, 5, v1
    v_mul_u32_u24 v6, 352, v6
    v_and_b32 v7, 31, v1
    v_lshl_add_u32 v6, v7, 4, v6
    v_cvt_pk_bf16_f32 v64, v96, v97
    v_cvt_pk_bf16_f32 v65, v98, v99
    v_cvt_pk_bf16_f32 v66, v100, v101
    v_cvt_pk_bf16_f32 v67, v102, v103
    v_cvt_pk_bf16_f32 v68, v104, v105
    v_cvt_pk_bf16_f32 v69, v106, v107
    v_cvt_pk_bf16_f32 v72, v112, v113
    v_cvt_pk_bf16_f32 v73, v114, v115
    v_cvt_pk_bf16_f32 v74, v116, v117
    v_cvt_pk_bf16_f32 v75, v118, v119
    v_cvt_pk_bf16_f32 v76, v120, v121
    v_cvt_pk_bf16_f32 v77, v122, v123
    v_cvt_pk_bf16_f32 v78, v124, v125
    v_cvt_pk_bf16_f32 v79, v126, v127
    buffer_store_dwordx4 v[64:67], v4, s[36:39], s60 offen offset:0 sc1
    v_cvt_pk_bf16_f32 v80, v144, v145
    v_cvt_pk_bf16_f32 v81, v146, v147
    v_cvt_pk_bf16_f32 v82, v148, v149
    v_cvt_pk_bf16_f32 v83, v150, v151
    v_cvt_pk_bf16_f32 v84, v152, v153
    v_cvt_pk_bf16_f32 v85, v154, v155
    v_cvt_pk_bf16_f32 v88, v160, v161
    v_cvt_pk_bf16_f32 v89, v162, v163
    v_cvt_pk_bf16_f32 v90, v164, v165
    v_cvt_pk_bf16_f32 v91, v166, v167
    v_cvt_pk_bf16_f32 v92, v168, v169
    v_cvt_pk_bf16_f32 v93, v170, v171
    v_cvt_pk_bf16_f32 v94, v172, v173
    v_cvt_pk_bf16_f32 v95, v174, v175
    buffer_store_dwordx4 v[80:83], v4, s[36:39], s60 offen offset:1024 sc1
    s_mov_b32 exec_hi, 0
    buffer_store_dwordx2 v[68:69], v5, s[36:39], s61 offen offset:0 sc1
    buffer_store_dwordx2 v[84:85], v5, s[36:39], s61 offen offset:256 sc1
    s_mov_b32 exec_lo, 0x00100000
    s_mov_b32 exec_hi, 0x00100000
    s_mov_b32 s74, 0x3f803f80
    s_mov_b32 s75, 0x3f803f80
    v_mov_b64 v[72:73], s[74:75]
    v_mov_b64 v[74:75], s[74:75]
    v_mov_b64 v[76:77], s[74:75]
    v_mov_b64 v[78:79], s[74:75]
    v_mov_b64 v[88:89], s[74:75]
    v_mov_b64 v[90:91], s[74:75]
    v_mov_b64 v[92:93], s[74:75]
    v_mov_b64 v[94:95], s[74:75]
    s_mov_b32 exec_lo, 0x00200000
    s_mov_b32 exec_hi, 0x00200000
    v_mov_b64 v[72:73], 0
    v_mov_b64 v[74:75], 0
    v_mov_b64 v[76:77], 0
    v_mov_b64 v[78:79], 0
    v_mov_b64 v[88:89], 0
    v_mov_b64 v[90:91], 0
    v_mov_b64 v[92:93], 0
    v_mov_b64 v[94:95], 0
    s_mov_b32 exec_lo, 0x003fffff
    s_mov_b32 exec_hi, 0x003fffff
    buffer_store_dwordx4 v[72:75], v6, s[36:39], s62 offen offset:0 sc1
    buffer_store_dwordx4 v[76:79], v6, s[36:39], s62 offen offset:704 sc1
    buffer_store_dwordx4 v[88:91], v6, s[36:39], s62 offen offset:1408 sc1
    buffer_store_dwordx4 v[92:95], v6, s[36:39], s62 offen offset:2112 sc1
    s_mov_b64 exec, -1
    s_lshl_b32 s59, s54, 7
    s_add_u32 s59, s59, 14974976
    v_mov_b32 v3, 1
    s_waitcnt vmcnt(0)
    s_mov_b64 exec, 1
    ds_add_rtn_u32 v3, v2, v3 offset:4
    s_mov_b64 exec, -1
    v_lshlrev_b32 v2, 11, v1
    s_waitcnt lgkmcnt(0)
    v_readfirstlane_b32 s60, v3
    s_nop 3
    s_cmp_lg_u32 s60, 1
    s_cbranch_scc1 GA_E1
    s_mov_b64 exec, 0xff
    buffer_store_dword v17, v2, s[36:39], s59 offen sc1
    s_mov_b64 exec, -1
    s_branch GA_E1
GA_FALLBACK:
    v_mov_b32 v160, 0xff800000
    v_mov_b32 v161, 0xff800000
    v_mov_b32 v192, 0
    v_mov_b32 v193, 0
    v_mov_b32 v194, 0
    v_mov_b32 v195, 0
    v_mov_b32 v196, 0
    v_mov_b32 v197, 0
    v_mov_b32 v198, 0
    v_mov_b32 v199, 0
    v_mov_b32 v200, 0
    v_mov_b32 v201, 0
    v_mov_b32 v202, 0
    v_mov_b32 v203, 0
    v_mov_b32 v204, 0
    v_mov_b32 v205, 0
    v_mov_b32 v206, 0
    v_mov_b32 v207, 0
    v_mov_b32 v208, 0
    v_mov_b32 v209, 0
    v_mov_b32 v210, 0
    v_mov_b32 v211, 0
    v_mov_b32 v212, 0
    v_mov_b32 v213, 0
    v_mov_b32 v214, 0
    v_mov_b32 v215, 0
    v_mov_b32 v216, 0
    v_mov_b32 v217, 0
    v_mov_b32 v218, 0
    v_mov_b32 v219, 0
    v_mov_b32 v220, 0
    v_mov_b32 v221, 0
    v_mov_b32 v222, 0
    v_mov_b32 v223, 0
    s_mov_b32 s67, 0
GA_FB_PASS:
    s_mov_b32 s68, 0
GA_FB_TILE:
    s_lshr_b32 s59, s68, 2
    s_mul_i32 s59, s59, 10752
    s_add_u32 s59, s59, 14680064
    s_and_b32 s60, s68, 3
    s_lshl_b32 s61, s60, 10
    s_add_u32 s61, s61, s59
    buffer_load_dwordx4 v[32:35], v224, s[36:39], s61 offen sc1
    s_lshl_b32 s61, s60, 8
    s_add_u32 s61, s61, s59
    s_add_u32 s61, s61, 4096
    buffer_load_dwordx2 v[40:41], v225, s[36:39], s61 offen sc1
    s_mul_i32 s61, s60, 1408
    s_add_u32 s61, s61, s59
    s_add_u32 s61, s61, 5120
    buffer_load_dwordx4 v[44:47], v226, s[36:39], s61 offen sc1
    buffer_load_dwordx4 v[48:51], v226, s[36:39], s61 offen offset:704 sc1
    s_waitcnt vmcnt(0)
    v_mfma_f32_32x32x4_2b_bf16 v[64:95], v[40:41], v[28:29], 0
    s_nop 15
    s_nop 3
    v_mfma_f32_32x32x16_bf16 v[64:79], v[32:35], v[20:23], v[64:79]
    v_mfma_f32_32x32x16_bf16 v[80:95], v[32:35], v[24:27], v[80:95]
    s_nop 15
    s_cmp_eq_u32 s67, 0
    s_cbranch_scc0 GA_FB_P2
    v_max3_f32 v160, v160, v64, v65
    v_max3_f32 v160, v160, v66, v67
    v_max3_f32 v160, v160, v68, v69
    v_max3_f32 v160, v160, v70, v71
    v_max3_f32 v160, v160, v72, v73
    v_max3_f32 v160, v160, v74, v75
    v_max3_f32 v160, v160, v76, v77
    v_max3_f32 v160, v160, v78, v79
    v_max3_f32 v161, v161, v80, v81
    v_max3_f32 v161, v161, v82, v83
    v_max3_f32 v161, v161, v84, v85
    v_max3_f32 v161, v161, v86, v87
    v_max3_f32 v161, v161, v88, v89
    v_max3_f32 v161, v161, v90, v91
    v_max3_f32 v161, v161, v92, v93
    v_max3_f32 v161, v161, v94, v95
    s_branch GA_FB_NEXT
GA_FB_P2:
    v_sub_f32 v64, v64, v160
    v_sub_f32 v65, v65, v160
    v_sub_f32 v66, v66, v160
    v_sub_f32 v67, v67, v160
    v_sub_f32 v68, v68, v160
    v_sub_f32 v69, v69, v160
    v_sub_f32 v70, v70, v160
    v_sub_f32 v71, v71, v160
    v_sub_f32 v72, v72, v160
    v_sub_f32 v73, v73, v160
    v_sub_f32 v74, v74, v160
    v_sub_f32 v75, v75, v160
    v_sub_f32 v76, v76, v160
    v_sub_f32 v77, v77, v160
    v_sub_f32 v78, v78, v160
    v_sub_f32 v79, v79, v160
    v_sub_f32 v80, v80, v161
    v_sub_f32 v81, v81, v161
    v_sub_f32 v82, v82, v161
    v_sub_f32 v83, v83, v161
    v_sub_f32 v84, v84, v161
    v_sub_f32 v85, v85, v161
    v_sub_f32 v86, v86, v161
    v_sub_f32 v87, v87, v161
    v_sub_f32 v88, v88, v161
    v_sub_f32 v89, v89, v161
    v_sub_f32 v90, v90, v161
    v_sub_f32 v91, v91, v161
    v_sub_f32 v92, v92, v161
    v_sub_f32 v93, v93, v161
    v_sub_f32 v94, v94, v161
    v_sub_f32 v95, v95, v161
    v_exp_f32 v64, v64
    v_exp_f32 v65, v65
    v_exp_f32 v66, v66
    v_exp_f32 v67, v67
    v_exp_f32 v68, v68
    v_exp_f32 v69, v69
    v_exp_f32 v70, v70
    v_exp_f32 v71, v71
    v_exp_f32 v72, v72
    v_exp_f32 v73, v73
    v_exp_f32 v74, v74
    v_exp_f32 v75, v75
    v_exp_f32 v76, v76
    v_exp_f32 v77, v77
    v_exp_f32 v78, v78
    v_exp_f32 v79, v79
    v_exp_f32 v80, v80
    v_exp_f32 v81, v81
    v_exp_f32 v82, v82
    v_exp_f32 v83, v83
    v_exp_f32 v84, v84
    v_exp_f32 v85, v85
    v_exp_f32 v86, v86
    v_exp_f32 v87, v87
    v_exp_f32 v88, v88
    v_exp_f32 v89, v89
    v_exp_f32 v90, v90
    v_exp_f32 v91, v91
    v_exp_f32 v92, v92
    v_exp_f32 v93, v93
    v_exp_f32 v94, v94
    v_exp_f32 v95, v95
    s_nop 1
    v_smfmac_f32_32x32x32_bf16 v[192:207], v[44:47], v[64:71], v233
    v_smfmac_f32_32x32x32_bf16 v[192:207], v[48:51], v[72:79], v233
    v_smfmac_f32_32x32x32_bf16 v[208:223], v[44:47], v[80:87], v233
    v_smfmac_f32_32x32x32_bf16 v[208:223], v[48:51], v[88:95], v233
    s_nop 15
GA_FB_NEXT:
    s_add_u32 s68, s68, 1
    s_cmp_lt_u32 s68, 64
    s_cbranch_scc1 GA_FB_TILE
    s_cmp_eq_u32 s67, 1
    s_cbranch_scc1 GA_FINAL
    v_mov_b32 v2, v160
    s_nop 1
    v_permlane32_swap_b32 v2, v160
    s_nop 1
    v_max_f32 v160, v160, v2
    v_mov_b32 v2, v161
    s_nop 1
    v_permlane32_swap_b32 v2, v161
    s_nop 1
    v_max_f32 v161, v161, v2
    s_mov_b32 s67, 1
    s_branch GA_FB_PASS
CODE_END:
.section .rodata,"a"
.p2align 6
.amdhsa_kernel gated_mix__sliding_local_dilated__grouped_kv_mqa__prompt_kernel
  .amdhsa_next_free_vgpr 256
  .amdhsa_next_free_sgpr 102
  .amdhsa_accum_offset 256
  .amdhsa_group_segment_fixed_size 0
  .amdhsa_kernarg_size 96
  .amdhsa_user_sgpr_count 2
  .amdhsa_user_sgpr_kernarg_segment_ptr 1
  .amdhsa_system_sgpr_workgroup_id_x 1
.end_amdhsa_kernel
```
